```python
import torch

def _softmax(x, axis=-1):
    return torch.softmax(x, dim=axis)
def _gelu(x):
    return torch.nn.functional.gelu(x, approximate="tanh")
def _silu(x):
    return torch.nn.functional.silu(x)
def _sigmoid(x):
    return torch.sigmoid(x)
def _layernorm(x, axis=-1, eps=1e-5):
    m = x.mean(dim=axis, keepdim=True)
    v = x.var(dim=axis, keepdim=True, unbiased=False)
    return (x - m) / torch.sqrt(v + eps)
def _scatter_add(tgt, idx, src, axis=0):
    return tgt.clone().index_add_(axis, idx, src)
def _segment_sum(src, seg, n):
    out = torch.zeros((n,) + src.shape[1:], dtype=src.dtype)
    return out.index_add_(0, seg, src)
def _pad(x, pw):
    flat = tuple(v for pair in reversed(pw) for v in pair)
    return torch.nn.functional.pad(x, flat)

kernel_name = 'sequential_preLN__gqa_block_cached__glu_gated_bilinear__decode'

def setup_inputs():

    _w = (lambda a: (lambda t: t.to(torch.bfloat16) if t.is_floating_point() else t)(torch.as_tensor(a)))
    def _A_setup():
        B, Sq, D = 1, 1, 512
        Hq, Hkv, Sk, Dh = 32, 8, 65536, 128
        assert Hq % Hkv == 0, (Hq, Hkv)
        return {
            "x": _w((lambda *s: torch.randn(*s, dtype=torch.bfloat16) * 0.05)(B, Sq, D)),
            "k_cache": _w((lambda *s: torch.randn(*s, dtype=torch.bfloat16) * 3.2)(B, Hkv, Sk, Dh)),
            "v_cache": _w((lambda *s: torch.randn(*s, dtype=torch.bfloat16) * 1.6)(B, Hkv, Sk, Dh)),
            "wq": _w((lambda *s: torch.randn(*s, dtype=torch.bfloat16) * 3.2)(D, Hq * Dh) * (D ** -0.5)),
            "wo": _w((lambda *s: torch.randn(*s, dtype=torch.bfloat16) * 1.6)(Hq * Dh, D) * ((Hq * Dh) ** -0.5)),
        }
    _A_in = _A_setup()

    def _B_setup():
        B, S, D, F = 1, 1, 512, 1792
        return {
            "x": _w((lambda *s: torch.randn(*s, dtype=torch.bfloat16) * 0.05)(B, S, D)),
            "w_gate": _w((lambda *s: torch.randn(*s, dtype=torch.bfloat16) * 1.6)(D, F) * (D ** -0.5)),
            "w_up": _w((lambda *s: torch.randn(*s, dtype=torch.bfloat16) * 1.6)(D, F) * (D ** -0.5)),
            "w_down": _w((lambda *s: torch.randn(*s, dtype=torch.bfloat16) * 1.6)(F, D) * (F ** -0.5)),
        }
    _B_in = _B_setup()

    return {
        "A_x": _A_in["x"],
        "A_k_cache": _A_in["k_cache"],
        "A_v_cache": _A_in["v_cache"],
        "A_wq": _A_in["wq"],
        "A_wo": _A_in["wo"],
        "B_x": _B_in["x"],
        "B_w_gate": _B_in["w_gate"],
        "B_w_up": _B_in["w_up"],
        "B_w_down": _B_in["w_down"],
    }

def reference(A_x, A_k_cache, A_v_cache, A_wq, A_wo, B_x, B_w_gate, B_w_up, B_w_down):
    def _A_ref(x, k_cache, v_cache, wq, wo):
        B, Sq, D = x.shape
        Hq, Dh = 32, 128
        Hkv = k_cache.shape[1]
        rep = Hq // Hkv
        q = (lambda x, *d: x.permute(*d))((x @ wq).reshape(B, Sq, Hq, Dh), 0, 2, 1, 3)
        k = (lambda x, n, axis: torch.repeat_interleave(x, n, dim=axis))(k_cache, rep, axis=1)
        v = (lambda x, n, axis: torch.repeat_interleave(x, n, dim=axis))(v_cache, rep, axis=1)
        scores = torch.einsum("bhqd,bhkd->bhqk", q, k) * (Dh ** -0.5)
        p = _softmax(scores, axis=-1)
        o = torch.einsum("bhqk,bhkd->bhqd", p, v)
        return (lambda x, *d: x.permute(*d))(o, 0, 2, 1, 3).reshape(B, Sq, Hq * Dh) @ wo

    def _B_ref(x, w_gate, w_up, w_down):
        g = torch.einsum("bsd,df->bsf", x, w_gate)
        u = torch.einsum("bsd,df->bsf", x, w_up)
        h = g * u
        return torch.einsum("bsf,fd->bsd", h, w_down)

    x = A_x
    h = x + _A_ref(_layernorm(x, axis=-1), A_k_cache, A_v_cache, A_wq, A_wo)
    h2 = h + _B_ref(_layernorm(h, axis=-1), B_w_gate, B_w_up, B_w_down)
    return h2
```

```asm
; @launch grid=(256,1,1) block=(512,1,1) lds=137216
.amdgcn_target "amdgcn-amd-amdhsa--gfx950"
.text
.globl sequential_preLN__gqa_block_cached__glu_gated_bilinear__decode_kernel
.p2align 8
.type sequential_preLN__gqa_block_cached__glu_gated_bilinear__decode_kernel,@function
sequential_preLN__gqa_block_cached__glu_gated_bilinear__decode_kernel:
    s_cmp_ge_u32 s2, 256
    s_cbranch_scc1 L_exit
    s_load_dwordx16 s[4:19], s[0:1], 0
    s_load_dwordx8 s[20:27], s[0:1], 64
    v_and_b32 v1, 63, v0
    v_lshrrev_b32 v44, 6, v0
    v_lshlrev_b32 v3, 4, v1
    v_readfirstlane_b32 s3, v44
    v_bfe_u32 v45, v1, 2, 2
    v_lshrrev_b32 v46, 4, v1
    v_and_b32 v47, 3, v1
    v_lshlrev_b32 v2, 8, v45
    v_lshl_add_u32 v2, v46, 6, v2
    v_lshl_add_u32 v2, v47, 4, v2
    v_add_u32 v244, 4096, v2
    s_lshr_b32 s77, s2, 3
    s_and_b32 s76, s77, 7
    s_and_b32 s73, s2, 7
    s_lshr_b32 s78, s2, 6
    s_lshl3_add_u32 s79, s78, s73
    s_cmp_ge_u32 s76, 4
    s_cselect_b32 s67, 6, 0
    s_sub_u32 s67, 264, s67
    s_mul_i32 s59, s78, 760
    s_mul_i32 s71, s73, 104
    s_add_u32 s59, s59, s71
    s_cmp_ge_u32 s77, 28
    s_cselect_b32 s68, 36, 60
    s_cmp_eq_u32 s73, 0
    s_cselect_b32 s71, 0, s68
    s_cselect_b32 s70, s68, 0
    s_sub_u32 s59, s59, s71
    s_cmp_gt_u32 s73, 2
    s_cselect_b32 s71, 12, 0
    s_sub_u32 s59, s59, s71
    s_cmp_eq_u32 s73, 2
    s_cselect_b32 s70, 12, s70
    s_cselect_b32 s65, 1, 0
    s_sub_u32 s70, 102, s70
    s_lshl_b32 s59, s59, 12
    s_lshl_b32 s70, s70, 12
    s_lshl_b32 s66, s3, 13
    s_add_u32 s66, s66, s59
    s_lshl_b32 s71, s76, 24
    s_mov_b32 s30, 16777216
    s_mov_b32 s31, 0x20000
    s_mov_b32 s34, 16777216
    s_mov_b32 s35, 0x20000
    s_cmp_lg_u32 s70, 417792
    s_cbranch_scc1 L_qprod
    s_waitcnt lgkmcnt(0)
    s_add_u32 s28, s6, s71
    s_addc_u32 s29, s7, 0
    s_add_u32 s32, s8, s71
    s_addc_u32 s33, s9, 0
    s_load_dword s52, s[26:27], 0
    s_cmp_eq_u32 s3, 0
    s_cbranch_scc1 L_w0
L_ring:
    buffer_load_dwordx4 v[56:59], v2, s[28:31], s66 offen offset:0 nt
    buffer_load_dwordx4 v[60:63], v2, s[28:31], s66 offen offset:1024 nt
    buffer_load_dwordx4 v[64:67], v2, s[28:31], s66 offen offset:2048 nt
    buffer_load_dwordx4 v[68:71], v2, s[28:31], s66 offen offset:3072 nt
    buffer_load_dwordx4 v[72:75], v244, s[28:31], s66 offen offset:0 nt
    buffer_load_dwordx4 v[76:79], v244, s[28:31], s66 offen offset:1024 nt
    buffer_load_dwordx4 v[80:83], v244, s[28:31], s66 offen offset:2048 nt
    buffer_load_dwordx4 v[84:87], v244, s[28:31], s66 offen offset:3072 nt
    s_add_u32 s68, s66, 57344
    buffer_load_dwordx4 v[88:91], v2, s[28:31], s68 offen offset:0 nt
    buffer_load_dwordx4 v[92:95], v2, s[28:31], s68 offen offset:1024 nt
    buffer_load_dwordx4 v[96:99], v2, s[28:31], s68 offen offset:2048 nt
    buffer_load_dwordx4 v[100:103], v2, s[28:31], s68 offen offset:3072 nt
    buffer_load_dwordx4 v[104:107], v244, s[28:31], s68 offen offset:0 nt
    buffer_load_dwordx4 v[108:111], v244, s[28:31], s68 offen offset:1024 nt
    buffer_load_dwordx4 v[112:115], v244, s[28:31], s68 offen offset:2048 nt
    buffer_load_dwordx4 v[116:119], v244, s[28:31], s68 offen offset:3072 nt
    s_add_u32 s68, s68, 57344
    s_and_b32 s71, s2, 7
    s_cbranch_scc0 L_ringe
    buffer_load_dwordx4 v[120:123], v2, s[28:31], s68 offen offset:0 nt
    buffer_load_dwordx4 v[124:127], v2, s[28:31], s68 offen offset:1024 nt
    buffer_load_dwordx4 v[128:131], v2, s[28:31], s68 offen offset:2048 nt
    buffer_load_dwordx4 v[132:135], v2, s[28:31], s68 offen offset:3072 nt
    buffer_load_dwordx4 v[136:139], v244, s[28:31], s68 offen offset:0 nt
    buffer_load_dwordx4 v[140:143], v244, s[28:31], s68 offen offset:1024 nt
    buffer_load_dwordx4 v[144:147], v244, s[28:31], s68 offen offset:2048 nt
    buffer_load_dwordx4 v[148:151], v244, s[28:31], s68 offen offset:3072 nt
    s_add_u32 s68, s68, 57344
    buffer_load_dwordx4 v[152:155], v2, s[28:31], s68 offen offset:0 nt
    buffer_load_dwordx4 v[156:159], v2, s[28:31], s68 offen offset:1024 nt
    buffer_load_dwordx4 v[160:163], v2, s[28:31], s68 offen offset:2048 nt
    buffer_load_dwordx4 v[164:167], v2, s[28:31], s68 offen offset:3072 nt
    buffer_load_dwordx4 v[168:171], v244, s[28:31], s68 offen offset:0 nt
    buffer_load_dwordx4 v[172:175], v244, s[28:31], s68 offen offset:1024 nt
    buffer_load_dwordx4 v[176:179], v244, s[28:31], s68 offen offset:2048 nt
    buffer_load_dwordx4 v[180:183], v244, s[28:31], s68 offen offset:3072 nt
    s_add_u32 s68, s68, 57344
    buffer_load_dwordx4 v[184:187], v2, s[28:31], s68 offen offset:0 nt
    buffer_load_dwordx4 v[188:191], v2, s[28:31], s68 offen offset:1024 nt
    buffer_load_dwordx4 v[192:195], v2, s[28:31], s68 offen offset:2048 nt
    buffer_load_dwordx4 v[196:199], v2, s[28:31], s68 offen offset:3072 nt
    buffer_load_dwordx4 v[200:203], v244, s[28:31], s68 offen offset:0 nt
    buffer_load_dwordx4 v[204:207], v244, s[28:31], s68 offen offset:1024 nt
    buffer_load_dwordx4 v[208:211], v244, s[28:31], s68 offen offset:2048 nt
    buffer_load_dwordx4 v[212:215], v244, s[28:31], s68 offen offset:3072 nt
L_ringe:
    s_mov_b32 s48, s4
    s_mov_b32 s49, s5
    s_mov_b32 s50, 0x400
    s_mov_b32 s51, 0x20000
    s_mov_b32 s36, s26
    s_mov_b32 s37, s27
    s_mov_b32 s38, 0x180000
    s_mov_b32 s39, 0x20000
    s_mov_b32 s60, 0x22222222
    s_mov_b32 s61, 0x22222222
    s_mov_b32 s62, 0x44444444
    s_mov_b32 s63, 0x44444444
    s_mov_b32 s64, 0x88888888
    s_mov_b32 s65, 0x88888888
    s_mov_b32 s74, 0x3db504f3
    s_mov_b32 s75, 0x3fb8aa3b
    s_mov_b32 s72, 1048576
    v_mov_b32 v44, 0xffff
    v_mov_b32 v45, 0xffff0000
    v_mov_b32 v4, 0
    v_mov_b32 v5, 0
    v_cmp_eq_u32 vcc, 0, v47
    s_nop 1
    v_cndmask_b32 v4, v4, v44, vcc
    v_cndmask_b32 v4, v4, v45, s[60:61]
    v_cndmask_b32 v5, v5, v44, s[62:63]
    v_cndmask_b32 v5, v5, v45, s[64:65]
    v_mov_b32 v10, 0
    v_mov_b32 v11, 0
    v_mov_b32 v12, 0
    v_mov_b32 v13, 0
    v_mov_b32 v14, 0
    v_mov_b32 v15, 0
    v_mov_b32 v16, 0
    v_mov_b32 v17, 0
    v_mov_b32 v18, 0xff7fffff
    v_mov_b32 v19, 0
    s_waitcnt lgkmcnt(0)
    s_add_u32 s52, s52, 0x9e3779b9
    s_and_b32 s53, s52, 0xff
    s_bfe_u32 s54, s52, 0x80008
    s_bfe_u32 s55, s52, 0x80010
    s_lshr_b32 s56, s52, 24
    s_and_b32 s57, s52, 0xffff
    s_lshr_b32 s58, s52, 16
    s_barrier
    s_branch L_qj
L_qprod:
    v_lshrrev_b32 v44, 3, v1
    v_and_b32 v45, 7, v1
    v_lshlrev_b32 v50, 16, v44
    v_lshl_add_u32 v50, v45, 4, v50
    v_lshlrev_b32 v51, 4, v44
    s_lshl1_add_u32 s69, s78, s65
    s_lshl3_add_u32 s69, s76, s69
    s_lshl_b32 s68, s69, 7
    s_lshl_b32 s73, s3, 19
    s_add_u32 s68, s68, s73
    s_lshl_b32 s73, s3, 7
    s_mov_b32 s50, 1024
    s_mov_b32 s51, 0x20000
    s_mov_b32 s42, 4194304
    s_mov_b32 s43, 0x20000
    v_add_u32 v36, 8192, v50
    v_add_u32 v37, 16384, v50
    v_add_u32 v38, 24576, v50
    v_add_u32 v39, 32768, v50
    v_add_u32 v40, 40960, v50
    v_add_u32 v41, 49152, v50
    v_add_u32 v42, 57344, v50
    s_waitcnt lgkmcnt(0)
    s_mov_b32 s48, s4
    s_mov_b32 s49, s5
    s_mov_b32 s40, s10
    s_mov_b32 s41, s11
    buffer_load_dwordx4 v[52:55], v3, s[48:51], 0 offen
    buffer_load_dwordx4 v[32:35], v51, s[48:51], s73 offen
    buffer_load_dwordx4 v[56:59], v50, s[40:43], s68 offen nt
    buffer_load_dwordx4 v[60:63], v36, s[40:43], s68 offen nt
    buffer_load_dwordx4 v[64:67], v37, s[40:43], s68 offen nt
    buffer_load_dwordx4 v[68:71], v38, s[40:43], s68 offen nt
    buffer_load_dwordx4 v[72:75], v39, s[40:43], s68 offen nt
    buffer_load_dwordx4 v[76:79], v40, s[40:43], s68 offen nt
    buffer_load_dwordx4 v[80:83], v41, s[40:43], s68 offen nt
    buffer_load_dwordx4 v[84:87], v42, s[40:43], s68 offen nt
    s_load_dword s52, s[26:27], 0
    s_add_u32 s28, s6, s71
    s_addc_u32 s29, s7, 0
    s_add_u32 s32, s8, s71
    s_addc_u32 s33, s9, 0
    s_cmp_lg_u32 s3, 0
    s_cbranch_scc1 L_nz
    s_cmp_lg_u32 s65, 0
    s_cbranch_scc1 L_nz
    s_mul_i32 s73, s77, 256
    s_add_u32 s73, s73, 851968
    v_mov_b32 v49, s73
    v_mov_b32 v48, 0
    s_mov_b64 exec, 1
    global_store_dword v49, v48, s[26:27] sc1
    s_mov_b64 exec, -1
L_nz:
    v_lshrrev_b32 v49, 5, v1
    v_and_b32 v44, 1, v46
    v_lshlrev_b32 v48, 8, v49
    v_lshl_add_u32 v48, v45, 5, v48
    v_lshl_add_u32 v48, v44, 4, v48
    s_lshl_b32 s73, s3, 9
    v_add_u32 v48, s73, v48
    s_mov_b32 s60, 0x22222222
    s_mov_b32 s61, 0x22222222
    s_mov_b32 s62, 0x44444444
    s_mov_b32 s63, 0x44444444
    s_mov_b32 s64, 0x88888888
    s_mov_b32 s65, 0x88888888
    s_mov_b32 s74, 0x3db504f3
    s_mov_b32 s75, 0x3fb8aa3b
    s_mov_b32 s72, 1048576
    v_mov_b32 v44, 0xffff
    v_mov_b32 v45, 0xffff0000
    v_mov_b32 v4, 0
    v_mov_b32 v5, 0
    v_cmp_eq_u32 vcc, 0, v47
    s_nop 1
    v_cndmask_b32 v4, v4, v44, vcc
    v_cndmask_b32 v4, v4, v45, s[60:61]
    v_cndmask_b32 v5, v5, v44, s[62:63]
    v_cndmask_b32 v5, v5, v45, s[64:65]
    v_mov_b32 v10, 0
    v_mov_b32 v11, 0
    v_mov_b32 v12, 0
    v_mov_b32 v13, 0
    v_mov_b32 v14, 0
    v_mov_b32 v15, 0
    v_mov_b32 v16, 0
    v_mov_b32 v17, 0
    v_mov_b32 v18, 0xff7fffff
    v_mov_b32 v19, 0
    v_bfe_u32 v51, v1, 2, 1
    v_cmp_eq_u32 vcc, 0, v51
    s_nop 1
    v_cndmask_b32 v6, 0, v4, vcc
    v_cndmask_b32 v7, 0, v5, vcc
    v_cndmask_b32 v8, v4, 0, vcc
    v_cndmask_b32 v9, v5, 0, vcc
    s_waitcnt vmcnt(8)
    v_lshlrev_b32 v36, 16, v52
    v_and_b32 v37, 0xffff0000, v52
    v_lshlrev_b32 v38, 16, v53
    v_and_b32 v39, 0xffff0000, v53
    v_lshlrev_b32 v40, 16, v54
    v_and_b32 v41, 0xffff0000, v54
    v_lshlrev_b32 v42, 16, v55
    v_and_b32 v43, 0xffff0000, v55
    v_lshlrev_b32 v20, 16, v32
    v_and_b32 v21, 0xffff0000, v32
    v_lshlrev_b32 v22, 16, v33
    v_and_b32 v23, 0xffff0000, v33
    v_lshlrev_b32 v24, 16, v34
    v_and_b32 v25, 0xffff0000, v34
    v_lshlrev_b32 v26, 16, v35
    v_and_b32 v27, 0xffff0000, v35
    v_add_f32 v44, v36, v37
    v_add_f32 v51, v38, v39
    v_add_f32 v45, v40, v41
    v_add_f32 v44, v44, v51
    v_add_f32 v51, v42, v43
    v_add_f32 v45, v45, v51
    v_add_f32 v44, v44, v45
    s_nop 1
    v_add_f32_dpp v44, v44, v44 quad_perm:[1,0,3,2] row_mask:0xf bank_mask:0xf
    s_nop 1
    v_add_f32_dpp v44, v44, v44 quad_perm:[2,3,0,1] row_mask:0xf bank_mask:0xf
    s_nop 1
    v_add_f32_dpp v44, v44, v44 row_ror:8 row_mask:0xf bank_mask:0xf
    s_nop 1
    v_add_f32_dpp v44, v44, v44 row_ror:4 row_mask:0xf bank_mask:0xf
    v_mov_b32 v51, v44
    s_nop 1
    v_permlane32_swap_b32 v44, v51
    v_add_f32 v44, v44, v51
    v_mov_b32 v51, v44
    s_nop 1
    v_permlane16_swap_b32 v44, v51
    v_add_f32 v44, v44, v51
    v_mul_f32 v44, 0x3b000000, v44
    v_sub_f32 v36, v36, v44
    v_sub_f32 v37, v37, v44
    v_sub_f32 v38, v38, v44
    v_sub_f32 v39, v39, v44
    v_sub_f32 v40, v40, v44
    v_sub_f32 v41, v41, v44
    v_sub_f32 v42, v42, v44
    v_sub_f32 v43, v43, v44
    v_mul_f32 v45, v36, v36
    v_mul_f32 v51, v37, v37
    v_fmac_f32 v45, v38, v38
    v_fmac_f32 v51, v39, v39
    v_fmac_f32 v45, v40, v40
    v_fmac_f32 v51, v41, v41
    v_fmac_f32 v45, v42, v42
    v_fmac_f32 v51, v43, v43
    v_add_f32 v45, v45, v51
    s_nop 1
    v_add_f32_dpp v45, v45, v45 quad_perm:[1,0,3,2] row_mask:0xf bank_mask:0xf
    s_nop 1
    v_add_f32_dpp v45, v45, v45 quad_perm:[2,3,0,1] row_mask:0xf bank_mask:0xf
    s_nop 1
    v_add_f32_dpp v45, v45, v45 row_ror:8 row_mask:0xf bank_mask:0xf
    s_nop 1
    v_add_f32_dpp v45, v45, v45 row_ror:4 row_mask:0xf bank_mask:0xf
    v_mov_b32 v51, v45
    s_nop 1
    v_permlane32_swap_b32 v45, v51
    v_add_f32 v45, v45, v51
    v_mov_b32 v51, v45
    s_nop 1
    v_permlane16_swap_b32 v45, v51
    v_add_f32 v45, v45, v51
    v_mul_f32 v45, 0x3b000000, v45
    v_cvt_pk_bf16_f32 v45, 0, v45
    v_cvt_pk_bf16_f32 v44, 0, v44
    v_add_f32 v45, 0x37280000, v45
    v_cvt_pk_bf16_f32 v45, 0, v45
    v_sqrt_f32 v45, v45
    s_nop 0
    v_cvt_pk_bf16_f32 v45, 0, v45
    v_rcp_f32 v45, v45
    v_sub_f32 v20, v20, v44
    v_sub_f32 v21, v21, v44
    v_sub_f32 v22, v22, v44
    v_sub_f32 v23, v23, v44
    v_sub_f32 v24, v24, v44
    v_sub_f32 v25, v25, v44
    v_sub_f32 v26, v26, v44
    v_sub_f32 v27, v27, v44
    v_cvt_pk_bf16_f32 v20, 0, v20
    v_cvt_pk_bf16_f32 v21, 0, v21
    v_cvt_pk_bf16_f32 v22, 0, v22
    v_cvt_pk_bf16_f32 v23, 0, v23
    v_cvt_pk_bf16_f32 v24, 0, v24
    v_cvt_pk_bf16_f32 v25, 0, v25
    v_cvt_pk_bf16_f32 v26, 0, v26
    v_cvt_pk_bf16_f32 v27, 0, v27
    v_mul_f32 v20, v20, v45
    v_mul_f32 v21, v21, v45
    v_mul_f32 v22, v22, v45
    v_mul_f32 v23, v23, v45
    v_mul_f32 v24, v24, v45
    v_mul_f32 v25, v25, v45
    v_mul_f32 v26, v26, v45
    v_mul_f32 v27, v27, v45
    v_cvt_pk_bf16_f32 v20, v20, v20
    v_cvt_pk_bf16_f32 v21, v21, v21
    v_cvt_pk_bf16_f32 v22, v22, v22
    v_cvt_pk_bf16_f32 v23, v23, v23
    v_cvt_pk_bf16_f32 v24, v24, v24
    v_cvt_pk_bf16_f32 v25, v25, v25
    v_cvt_pk_bf16_f32 v26, v26, v26
    v_cvt_pk_bf16_f32 v27, v27, v27
    v_and_b32 v88, v20, v6
    v_and_b32 v89, v20, v7
    v_and_b32 v90, v20, v8
    v_and_b32 v91, v20, v9
    v_and_b32 v92, v21, v6
    v_and_b32 v93, v21, v7
    v_and_b32 v94, v21, v8
    v_and_b32 v95, v21, v9
    v_and_b32 v96, v22, v6
    v_and_b32 v97, v22, v7
    v_and_b32 v98, v22, v8
    v_and_b32 v99, v22, v9
    v_and_b32 v100, v23, v6
    v_and_b32 v101, v23, v7
    v_and_b32 v102, v23, v8
    v_and_b32 v103, v23, v9
    v_and_b32 v104, v24, v6
    v_and_b32 v105, v24, v7
    v_and_b32 v106, v24, v8
    v_and_b32 v107, v24, v9
    v_and_b32 v108, v25, v6
    v_and_b32 v109, v25, v7
    v_and_b32 v110, v25, v8
    v_and_b32 v111, v25, v9
    v_and_b32 v112, v26, v6
    v_and_b32 v113, v26, v7
    v_and_b32 v114, v26, v8
    v_and_b32 v115, v26, v9
    v_and_b32 v116, v27, v6
    v_and_b32 v117, v27, v7
    v_and_b32 v118, v27, v8
    v_and_b32 v119, v27, v9
    s_waitcnt vmcnt(0)
    v_mfma_f32_16x16x32_bf16 v[28:31], v[88:91], v[56:59], 0
    v_mfma_f32_16x16x32_bf16 v[28:31], v[92:95], v[60:63], v[28:31]
    v_mfma_f32_16x16x32_bf16 v[28:31], v[96:99], v[64:67], v[28:31]
    v_mfma_f32_16x16x32_bf16 v[28:31], v[100:103], v[68:71], v[28:31]
    v_mfma_f32_16x16x32_bf16 v[28:31], v[104:107], v[72:75], v[28:31]
    v_mfma_f32_16x16x32_bf16 v[28:31], v[108:111], v[76:79], v[28:31]
    v_mfma_f32_16x16x32_bf16 v[28:31], v[112:115], v[80:83], v[28:31]
    v_mfma_f32_16x16x32_bf16 v[28:31], v[116:119], v[84:87], v[28:31]
    s_mov_b32 exec_lo, 0x00ff00ff
    s_mov_b32 exec_hi, 0xff00ff00
    s_nop 5
    ds_write_b128 v48, v[28:31] offset:20480
    s_mov_b64 exec, -1
    s_waitcnt lgkmcnt(0)
    s_barrier
    s_cmp_lg_u32 s3, 0
    s_cbranch_scc1 L_ringb
    s_setprio 3
    v_and_b32 v50, 15, v1
    v_lshlrev_b32 v49, 10, v46
    v_lshl_add_u32 v49, v50, 4, v49
    ds_read_b128 v[20:23], v49 offset:20480
    ds_read_b128 v[24:27], v49 offset:20736
    ds_read_b128 v[28:31], v49 offset:20992
    ds_read_b128 v[32:35], v49 offset:21248
    s_mov_b32 s36, s26
    s_mov_b32 s37, s27
    s_mov_b32 s38, 0x180000
    s_mov_b32 s39, 0x20000
    s_add_u32 s52, s52, 0x9e3779b9
    s_and_b32 s53, s52, 0xff
    s_bfe_u32 s54, s52, 0x80008
    s_bfe_u32 s55, s52, 0x80010
    s_lshr_b32 s56, s52, 24
    s_and_b32 s57, s52, 0xffff
    s_lshr_b32 s58, s52, 16
    v_and_b32 v45, 1, v46
    v_lshlrev_b32 v45, 1, v45
    v_lshrrev_b32 v44, 1, v46
    v_or_b32 v45, v45, v44
    v_lshl_add_u32 v45, v50, 2, v45
    v_lshlrev_b32 v45, 2, v45
    v_mov_b32 v49, s57
    v_mov_b32 v51, s58
    v_cmp_eq_u32 vcc, 0, v44
    s_nop 1
    v_cndmask_b32 v49, v51, v49, vcc
    s_lshl_b32 s71, s69, 8
    s_add_u32 s71, s71, 4096
    s_waitcnt lgkmcnt(0)
    v_pk_add_f32 v[20:21], v[20:21], v[24:25]
    v_pk_add_f32 v[22:23], v[22:23], v[26:27]
    v_pk_add_f32 v[28:29], v[28:29], v[32:33]
    v_pk_add_f32 v[30:31], v[30:31], v[34:35]
    v_pk_add_f32 v[20:21], v[20:21], v[28:29]
    v_pk_add_f32 v[22:23], v[22:23], v[30:31]
    s_nop 0
    v_permlane32_swap_b32 v20, v21
    v_permlane32_swap_b32 v22, v23
    v_add_f32 v20, v20, v21
    v_add_f32 v22, v22, v23
    s_nop 1
    v_permlane16_swap_b32 v20, v22
    v_add_f32 v20, v20, v22
    v_cvt_pk_bf16_f32 v20, 0, v20
    v_or_b32 v20, v20, v49
    buffer_store_dword v20, v45, s[36:39], s71 offen sc1
    s_barrier
    s_branch L_w0b
L_ringb:
    s_barrier
    s_branch L_ring
L_w0:
    s_setprio 3
    s_mov_b32 s48, s4
    s_mov_b32 s49, s5
    s_mov_b32 s50, 0x400
    s_mov_b32 s51, 0x20000
    s_mov_b32 s36, s26
    s_mov_b32 s37, s27
    s_mov_b32 s38, 0x180000
    s_mov_b32 s39, 0x20000
    s_mov_b32 s60, 0x22222222
    s_mov_b32 s61, 0x22222222
    s_mov_b32 s62, 0x44444444
    s_mov_b32 s63, 0x44444444
    s_mov_b32 s64, 0x88888888
    s_mov_b32 s65, 0x88888888
    s_mov_b32 s74, 0x3db504f3
    s_mov_b32 s75, 0x3fb8aa3b
    s_mov_b32 s72, 1048576
    v_mov_b32 v44, 0xffff
    v_mov_b32 v45, 0xffff0000
    v_mov_b32 v4, 0
    v_mov_b32 v5, 0
    v_cmp_eq_u32 vcc, 0, v47
    s_nop 1
    v_cndmask_b32 v4, v4, v44, vcc
    v_cndmask_b32 v4, v4, v45, s[60:61]
    v_cndmask_b32 v5, v5, v44, s[62:63]
    v_cndmask_b32 v5, v5, v45, s[64:65]
    v_mov_b32 v10, 0
    v_mov_b32 v11, 0
    v_mov_b32 v12, 0
    v_mov_b32 v13, 0
    v_mov_b32 v14, 0
    v_mov_b32 v15, 0
    v_mov_b32 v16, 0
    v_mov_b32 v17, 0
    v_mov_b32 v18, 0xff7fffff
    v_mov_b32 v19, 0
    s_waitcnt lgkmcnt(0)
    s_add_u32 s52, s52, 0x9e3779b9
    s_and_b32 s53, s52, 0xff
    s_bfe_u32 s54, s52, 0x80008
    s_bfe_u32 s55, s52, 0x80010
    s_lshr_b32 s56, s52, 24
    s_and_b32 s57, s52, 0xffff
    s_lshr_b32 s58, s52, 16
L_w0b:
    s_and_b32 s71, s2, 7
    s_cselect_b32 s71, 36, 15
    s_lshl_b32 s71, s71, 13
    v_mov_b32 v52, 18944
    v_mov_b32 v48, s71
    ds_write_b32 v52, v48
    v_mov_b32 v24, -1
    v_mov_b32 v25, -1
    v_mov_b32 v26, -1
    v_mov_b32 v27, -1
    s_lshl_b32 s71, s76, 15
    s_lshl_b32 s73, s79, 10
    s_add_u32 s71, s71, s73
    s_add_u32 s71, s71, 65536
    buffer_store_dwordx4 v[24:27], v3, s[36:39], s71 offen sc1
    ds_write_b128 v3, v[24:27] offset:36864
    ds_write_b128 v3, v[24:27] offset:37888
    s_add_u32 s73, s59, s70
    v_lshlrev_b32 v28, 12, v1
    v_add_u32 v28, s73, v28
    v_lshlrev_b32 v29, 2, v1
    v_cmp_eq_u32 vcc, 0, v1
    s_nop 1
    v_addc_co_u32 v28, vcc, 0, v28, vcc
    s_mov_b64 exec, 3
    ds_write_b32 v29, v28 offset:36864
    s_mov_b64 exec, -1
    v_lshlrev_b32 v44, 1, v2
    s_lshl_b32 s71, s76, 11
    s_add_u32 s71, s71, 4096
    s_add_u32 s14, s26, s71
    s_addc_u32 s15, s27, 0
L_qhint:
    s_load_dword s40, s[14:15], 0 glc
    s_load_dword s41, s[14:15], 256 glc
    s_load_dword s42, s[14:15], 512 glc
    s_load_dword s43, s[14:15], 768 glc
    s_load_dword s44, s[14:15], 1024 glc
    s_load_dword s45, s[14:15], 1280 glc
    s_load_dword s46, s[14:15], 1536 glc
    s_load_dword s47, s[14:15], 1792 glc
    s_waitcnt lgkmcnt(0)
    s_xor_b32 s40, s40, s57
    s_xor_b32 s41, s41, s57
    s_xor_b32 s42, s42, s57
    s_xor_b32 s43, s43, s57
    s_xor_b32 s44, s44, s57
    s_xor_b32 s45, s45, s57
    s_xor_b32 s46, s46, s57
    s_xor_b32 s47, s47, s57
    s_or_b32 s40, s40, s41
    s_or_b32 s40, s40, s42
    s_or_b32 s40, s40, s43
    s_or_b32 s40, s40, s44
    s_or_b32 s40, s40, s45
    s_or_b32 s40, s40, s46
    s_or_b32 s40, s40, s47
    s_and_b32 s40, s40, 0xffff
    s_cbranch_scc0 L_qpoll
    s_sub_u32 s72, s72, 1
    s_cbranch_scc1 L_end
    s_sleep 4
    s_branch L_qhint
L_qpoll:
    buffer_load_dwordx4 v[20:23], v44, s[36:39], s71 offen sc1
    buffer_load_dwordx4 v[24:27], v44, s[36:39], s71 offen offset:16 sc1
    s_mov_b32 s73, 0x07060302
    s_waitcnt vmcnt(0)
    v_xor_b32 v20, s57, v20
    v_xor_b32 v21, s58, v21
    v_xor_b32 v22, s57, v22
    v_xor_b32 v23, s58, v23
    v_xor_b32 v24, s57, v24
    v_xor_b32 v25, s58, v25
    v_xor_b32 v26, s57, v26
    v_xor_b32 v27, s58, v27
    v_or3_b32 v45, v20, v21, v22
    v_or3_b32 v45, v45, v23, v24
    v_or3_b32 v45, v45, v25, v26
    v_or_b32 v45, v45, v27
    v_and_b32 v45, 0xffff, v45
    v_cmp_ne_u32 vcc, 0, v45
    s_cbranch_vccz L_q_ok
    s_sub_u32 s72, s72, 1
    s_cbranch_scc1 L_end
    s_branch L_qpoll
L_q_ok:
    v_perm_b32 v6, v21, v20, s73
    v_perm_b32 v7, v23, v22, s73
    v_perm_b32 v8, v25, v24, s73
    v_perm_b32 v9, v27, v26, s73
    ds_write_b128 v3, v[6:9] offset:17920
    s_waitcnt lgkmcnt(0)
    s_barrier
    buffer_load_dwordx4 v[56:59], v2, s[28:31], s66 offen offset:0 nt
    buffer_load_dwordx4 v[60:63], v2, s[28:31], s66 offen offset:1024 nt
    buffer_load_dwordx4 v[64:67], v2, s[28:31], s66 offen offset:2048 nt
    buffer_load_dwordx4 v[68:71], v2, s[28:31], s66 offen offset:3072 nt
    buffer_load_dwordx4 v[72:75], v244, s[28:31], s66 offen offset:0 nt
    buffer_load_dwordx4 v[76:79], v244, s[28:31], s66 offen offset:1024 nt
    buffer_load_dwordx4 v[80:83], v244, s[28:31], s66 offen offset:2048 nt
    buffer_load_dwordx4 v[84:87], v244, s[28:31], s66 offen offset:3072 nt
    s_setprio 0
L_qj:
    ds_read_b128 v[6:9], v3 offset:17920
    v_mov_b32 v52, 18944
    v_mov_b32 v53, 8192
    s_mov_b32 s69, 3
    s_mov_b32 s11, 0
    s_lshl_b32 s10, s70, 1
    v_add_u32 v245, 4096, v3
    s_lshr_b32 s71, s59, 4
    s_sub_u32 s71, 104448, s71
    v_lshl_add_u32 v246, v1, 2, s71
    s_mul_i32 s58, s77, 256
    s_add_u32 s58, s58, 851968
    s_sub_u32 s57, 4, s78
    s_mul_i32 s57, s57, s67
    s_sub_u32 s57, 4096, s57
    s_lshl_b32 s57, s57, 12
L_k:
    s_mov_b64 exec, 1
    ds_add_rtn_u32 v54, v52, v53
    s_mov_b64 exec, -1
    s_lshr_b32 s73, s66, 4
    v_add_u32 v48, s73, v246
    s_waitcnt vmcnt(4) lgkmcnt(0)
    v_readfirstlane_b32 s71, v54
    v_mfma_f32_16x16x32_bf16 v[20:23], v[56:59], v[6:9], 0
    v_mfma_f32_16x16x32_bf16 v[24:27], v[60:63], v[6:9], 0
    v_mfma_f32_16x16x32_bf16 v[28:31], v[64:67], v[6:9], 0
    v_mfma_f32_16x16x32_bf16 v[32:35], v[68:71], v[6:9], 0
    s_add_u32 s66, s71, s59
    s_cmp_ge_u32 s71, s70
    s_cbranch_scc1 L_k2v0
    buffer_load_dwordx4 v[56:59], v2, s[28:31], s66 offen offset:0 nt
    buffer_load_dwordx4 v[60:63], v2, s[28:31], s66 offen offset:1024 nt
    buffer_load_dwordx4 v[64:67], v2, s[28:31], s66 offen offset:2048 nt
    buffer_load_dwordx4 v[68:71], v2, s[28:31], s66 offen offset:3072 nt
L_k0r:
    v_cndmask_b32 v44, v20, v25, s[60:61]
    v_cndmask_b32 v45, v24, v29, s[60:61]
    v_cndmask_b32 v46, v28, v33, s[60:61]
    v_cndmask_b32 v47, v32, v21, s[60:61]
    v_cndmask_b32 v44, v44, v30, s[62:63]
    v_cndmask_b32 v45, v45, v34, s[62:63]
    v_cndmask_b32 v46, v46, v22, s[62:63]
    v_cndmask_b32 v47, v47, v26, s[62:63]
    v_cndmask_b32 v45, v45, v23, s[64:65]
    v_cndmask_b32 v46, v46, v27, s[64:65]
    v_cndmask_b32 v47, v47, v31, s[64:65]
    v_cndmask_b32 v44, v44, v35, s[64:65]
    v_add_f32_dpp v44, v45, v44 quad_perm:[3,0,1,2] row_mask:0xf bank_mask:0xf
    v_add_f32_dpp v44, v46, v44 quad_perm:[2,3,0,1] row_mask:0xf bank_mask:0xf
    v_add_f32_dpp v44, v47, v44 quad_perm:[1,2,3,0] row_mask:0xf bank_mask:0xf
    v_cvt_pk_bf16_f32 v44, 0, v44
    v_mul_f32 v44, s74, v44
    v_cvt_pk_bf16_f32 v44, 0, v44
    v_mul_f32 v44, s75, v44
    ds_write_b32 v48, v44 offset:0
    v_max_f32 v18, v18, v44
    s_waitcnt vmcnt(4)
    v_mfma_f32_16x16x32_bf16 v[20:23], v[72:75], v[6:9], 0
    v_mfma_f32_16x16x32_bf16 v[24:27], v[76:79], v[6:9], 0
    v_mfma_f32_16x16x32_bf16 v[28:31], v[80:83], v[6:9], 0
    v_mfma_f32_16x16x32_bf16 v[32:35], v[84:87], v[6:9], 0
    s_cmp_lg_u32 s11, 0
    s_cbranch_scc1 L_k2v1
    buffer_load_dwordx4 v[72:75], v244, s[28:31], s66 offen offset:0 nt
    buffer_load_dwordx4 v[76:79], v244, s[28:31], s66 offen offset:1024 nt
    buffer_load_dwordx4 v[80:83], v244, s[28:31], s66 offen offset:2048 nt
    buffer_load_dwordx4 v[84:87], v244, s[28:31], s66 offen offset:3072 nt
L_k1r:
    v_cndmask_b32 v44, v20, v25, s[60:61]
    v_cndmask_b32 v45, v24, v29, s[60:61]
    v_cndmask_b32 v46, v28, v33, s[60:61]
    v_cndmask_b32 v47, v32, v21, s[60:61]
    v_cndmask_b32 v44, v44, v30, s[62:63]
    v_cndmask_b32 v45, v45, v34, s[62:63]
    v_cndmask_b32 v46, v46, v22, s[62:63]
    v_cndmask_b32 v47, v47, v26, s[62:63]
    v_cndmask_b32 v45, v45, v23, s[64:65]
    v_cndmask_b32 v46, v46, v27, s[64:65]
    v_cndmask_b32 v47, v47, v31, s[64:65]
    v_cndmask_b32 v44, v44, v35, s[64:65]
    v_add_f32_dpp v44, v45, v44 quad_perm:[3,0,1,2] row_mask:0xf bank_mask:0xf
    v_add_f32_dpp v44, v46, v44 quad_perm:[2,3,0,1] row_mask:0xf bank_mask:0xf
    v_add_f32_dpp v44, v47, v44 quad_perm:[1,2,3,0] row_mask:0xf bank_mask:0xf
    v_cvt_pk_bf16_f32 v44, 0, v44
    v_mul_f32 v44, s74, v44
    v_cvt_pk_bf16_f32 v44, 0, v44
    v_mul_f32 v44, s75, v44
    ds_write_b32 v48, v44 offset:256
    v_max_f32 v18, v18, v44
    s_cmp_eq_u32 s69, 3
    s_cbranch_scc1 L_first
L_kn:
    s_cmp_eq_u32 s11, 0
    s_cbranch_scc1 L_k
    v_max_f32_dpp v18, v18, v18 quad_perm:[1,0,3,2] row_mask:0xf bank_mask:0xf
    s_nop 1
    v_max_f32_dpp v18, v18, v18 quad_perm:[2,3,0,1] row_mask:0xf bank_mask:0xf
    v_mov_b32 v49, v18
    s_nop 1
    v_permlane32_swap_b32 v18, v49
    v_max_f32 v18, v18, v49
    v_mov_b32 v49, v18
    s_nop 1
    v_permlane16_swap_b32 v18, v49
    v_max_f32 v18, v18, v49
    ds_write_b32 v218, v18 offset:16896
    v_and_b32 v49, 0x60, v218
    s_waitcnt lgkmcnt(0)
    s_barrier
    ds_read_b128 v[20:23], v49 offset:16896
    ds_read_b128 v[24:27], v49 offset:16912
    s_waitcnt lgkmcnt(0)
    v_max3_f32 v18, v20, v21, v22
    v_max3_f32 v18, v18, v23, v24
    v_max3_f32 v18, v18, v25, v26
    v_max_f32 v18, v18, v27
L_v:
    s_mov_b64 exec, 1
    ds_add_rtn_u32 v54, v52, v53
    s_mov_b64 exec, -1
    s_lshr_b32 s73, s66, 4
    v_add_u32 v48, s73, v246
    ds_read2_b32 v[20:21], v48 offset0:0 offset1:64
    s_waitcnt lgkmcnt(0)
    v_readfirstlane_b32 s71, v54
    v_sub_f32 v44, v20, v18
    v_exp_f32 v44, v44
    s_nop 0
    v_cvt_pk_bf16_f32 v45, v44, v44
    v_add_f32 v19, v19, v44
    s_nop 0
    v_and_b32_dpp v36, v45, v4 quad_perm:[0,0,0,0] row_mask:0xf bank_mask:0xf
    v_and_b32_dpp v37, v45, v5 quad_perm:[0,0,0,0] row_mask:0xf bank_mask:0xf
    v_and_b32_dpp v38, v45, v4 quad_perm:[1,1,1,1] row_mask:0xf bank_mask:0xf
    v_and_b32_dpp v39, v45, v5 quad_perm:[1,1,1,1] row_mask:0xf bank_mask:0xf
    v_and_b32_dpp v40, v45, v4 quad_perm:[2,2,2,2] row_mask:0xf bank_mask:0xf
    v_and_b32_dpp v41, v45, v5 quad_perm:[2,2,2,2] row_mask:0xf bank_mask:0xf
    v_and_b32_dpp v42, v45, v4 quad_perm:[3,3,3,3] row_mask:0xf bank_mask:0xf
    v_and_b32_dpp v43, v45, v5 quad_perm:[3,3,3,3] row_mask:0xf bank_mask:0xf
    s_waitcnt vmcnt(4)
    v_mfma_f32_16x16x16_bf16 v[10:13], v[36:37], v[56:57], v[10:13]
    v_mfma_f32_16x16x16_bf16 v[14:17], v[36:37], v[58:59], v[14:17]
    v_mfma_f32_16x16x16_bf16 v[10:13], v[38:39], v[60:61], v[10:13]
    v_mfma_f32_16x16x16_bf16 v[14:17], v[38:39], v[62:63], v[14:17]
    v_mfma_f32_16x16x16_bf16 v[10:13], v[40:41], v[64:65], v[10:13]
    v_mfma_f32_16x16x16_bf16 v[14:17], v[40:41], v[66:67], v[14:17]
    v_mfma_f32_16x16x16_bf16 v[10:13], v[42:43], v[68:69], v[10:13]
    v_mfma_f32_16x16x16_bf16 v[14:17], v[42:43], v[70:71], v[14:17]
    s_add_u32 s66, s71, s59
    s_sub_u32 s66, s66, s70
    s_cmp_ge_u32 s71, s10
    s_cbranch_scc1 L_v2c
    buffer_load_dwordx4 v[56:59], v3, s[32:35], s66 offen offset:0 nt
    buffer_load_dwordx4 v[60:63], v3, s[32:35], s66 offen offset:1024 nt
    buffer_load_dwordx4 v[64:67], v3, s[32:35], s66 offen offset:2048 nt
    buffer_load_dwordx4 v[68:71], v3, s[32:35], s66 offen offset:3072 nt
    v_sub_f32 v44, v21, v18
    v_exp_f32 v44, v44
    s_nop 0
    v_cvt_pk_bf16_f32 v45, v44, v44
    v_add_f32 v19, v19, v44
    s_nop 0
    v_and_b32_dpp v36, v45, v4 quad_perm:[0,0,0,0] row_mask:0xf bank_mask:0xf
    v_and_b32_dpp v37, v45, v5 quad_perm:[0,0,0,0] row_mask:0xf bank_mask:0xf
    v_and_b32_dpp v38, v45, v4 quad_perm:[1,1,1,1] row_mask:0xf bank_mask:0xf
    v_and_b32_dpp v39, v45, v5 quad_perm:[1,1,1,1] row_mask:0xf bank_mask:0xf
    v_and_b32_dpp v40, v45, v4 quad_perm:[2,2,2,2] row_mask:0xf bank_mask:0xf
    v_and_b32_dpp v41, v45, v5 quad_perm:[2,2,2,2] row_mask:0xf bank_mask:0xf
    v_and_b32_dpp v42, v45, v4 quad_perm:[3,3,3,3] row_mask:0xf bank_mask:0xf
    v_and_b32_dpp v43, v45, v5 quad_perm:[3,3,3,3] row_mask:0xf bank_mask:0xf
    s_waitcnt vmcnt(4)
    v_mfma_f32_16x16x16_bf16 v[10:13], v[36:37], v[72:73], v[10:13]
    v_mfma_f32_16x16x16_bf16 v[14:17], v[36:37], v[74:75], v[14:17]
    v_mfma_f32_16x16x16_bf16 v[10:13], v[38:39], v[76:77], v[10:13]
    v_mfma_f32_16x16x16_bf16 v[14:17], v[38:39], v[78:79], v[14:17]
    v_mfma_f32_16x16x16_bf16 v[10:13], v[40:41], v[80:81], v[10:13]
    v_mfma_f32_16x16x16_bf16 v[14:17], v[40:41], v[82:83], v[14:17]
    v_mfma_f32_16x16x16_bf16 v[10:13], v[42:43], v[84:85], v[10:13]
    v_mfma_f32_16x16x16_bf16 v[14:17], v[42:43], v[86:87], v[14:17]
    buffer_load_dwordx4 v[72:75], v245, s[32:35], s66 offen offset:0 nt
    buffer_load_dwordx4 v[76:79], v245, s[32:35], s66 offen offset:1024 nt
    buffer_load_dwordx4 v[80:83], v245, s[32:35], s66 offen offset:2048 nt
    buffer_load_dwordx4 v[84:87], v245, s[32:35], s66 offen offset:3072 nt
    s_branch L_v
L_k2v0:
    s_sub_u32 s66, s66, s70
    s_mov_b32 s11, 1
    buffer_load_dwordx4 v[56:59], v3, s[32:35], s66 offen offset:0 nt
    buffer_load_dwordx4 v[60:63], v3, s[32:35], s66 offen offset:1024 nt
    buffer_load_dwordx4 v[64:67], v3, s[32:35], s66 offen offset:2048 nt
    buffer_load_dwordx4 v[68:71], v3, s[32:35], s66 offen offset:3072 nt
    s_branch L_k0r
L_k2v1:
    buffer_load_dwordx4 v[72:75], v245, s[32:35], s66 offen offset:0 nt
    buffer_load_dwordx4 v[76:79], v245, s[32:35], s66 offen offset:1024 nt
    buffer_load_dwordx4 v[80:83], v245, s[32:35], s66 offen offset:2048 nt
    buffer_load_dwordx4 v[84:87], v245, s[32:35], s66 offen offset:3072 nt
    s_branch L_k1r
L_v2c:
    s_mov_b32 s11, 2
    s_branch L_dyn
L_vc0:
    s_mov_b32 s11, 3
    buffer_load_dwordx4 v[56:59], v2, s[28:31], s66 offen offset:0 nt
    buffer_load_dwordx4 v[60:63], v2, s[28:31], s66 offen offset:1024 nt
    buffer_load_dwordx4 v[64:67], v2, s[28:31], s66 offen offset:2048 nt
    buffer_load_dwordx4 v[68:71], v2, s[28:31], s66 offen offset:3072 nt
    v_sub_f32 v44, v21, v18
    v_exp_f32 v44, v44
    s_nop 0
    v_cvt_pk_bf16_f32 v45, v44, v44
    v_add_f32 v19, v19, v44
    s_nop 0
    v_and_b32_dpp v36, v45, v4 quad_perm:[0,0,0,0] row_mask:0xf bank_mask:0xf
    v_and_b32_dpp v37, v45, v5 quad_perm:[0,0,0,0] row_mask:0xf bank_mask:0xf
    v_and_b32_dpp v38, v45, v4 quad_perm:[1,1,1,1] row_mask:0xf bank_mask:0xf
    v_and_b32_dpp v39, v45, v5 quad_perm:[1,1,1,1] row_mask:0xf bank_mask:0xf
    v_and_b32_dpp v40, v45, v4 quad_perm:[2,2,2,2] row_mask:0xf bank_mask:0xf
    v_and_b32_dpp v41, v45, v5 quad_perm:[2,2,2,2] row_mask:0xf bank_mask:0xf
    v_and_b32_dpp v42, v45, v4 quad_perm:[3,3,3,3] row_mask:0xf bank_mask:0xf
    v_and_b32_dpp v43, v45, v5 quad_perm:[3,3,3,3] row_mask:0xf bank_mask:0xf
    s_waitcnt vmcnt(4)
    v_mfma_f32_16x16x16_bf16 v[10:13], v[36:37], v[72:73], v[10:13]
    v_mfma_f32_16x16x16_bf16 v[14:17], v[36:37], v[74:75], v[14:17]
    v_mfma_f32_16x16x16_bf16 v[10:13], v[38:39], v[76:77], v[10:13]
    v_mfma_f32_16x16x16_bf16 v[14:17], v[38:39], v[78:79], v[14:17]
    v_mfma_f32_16x16x16_bf16 v[10:13], v[40:41], v[80:81], v[10:13]
    v_mfma_f32_16x16x16_bf16 v[14:17], v[40:41], v[82:83], v[14:17]
    v_mfma_f32_16x16x16_bf16 v[10:13], v[42:43], v[84:85], v[10:13]
    v_mfma_f32_16x16x16_bf16 v[14:17], v[42:43], v[86:87], v[14:17]
    buffer_load_dwordx4 v[72:75], v3, s[32:35], s66 offen offset:0 nt
    buffer_load_dwordx4 v[76:79], v3, s[32:35], s66 offen offset:1024 nt
    buffer_load_dwordx4 v[80:83], v3, s[32:35], s66 offen offset:2048 nt
    buffer_load_dwordx4 v[84:87], v3, s[32:35], s66 offen offset:3072 nt
    s_cmp_ge_u32 s66, s30
    s_cbranch_scc1 L_done
L_loop:
    s_mov_b64 exec, 1
    ds_add_rtn_u32 v54, v52, v53
    s_mov_b64 exec, -1
    s_mov_b32 s11, 3
    s_waitcnt lgkmcnt(0)
    v_readfirstlane_b32 s71, v54
    s_branch L_dyn
L_gox:
    s_waitcnt vmcnt(4)
    v_mfma_f32_16x16x32_bf16 v[20:23], v[56:59], v[6:9], 0
    v_mfma_f32_16x16x32_bf16 v[24:27], v[60:63], v[6:9], 0
    v_mfma_f32_16x16x32_bf16 v[28:31], v[64:67], v[6:9], 0
    v_mfma_f32_16x16x32_bf16 v[32:35], v[68:71], v[6:9], 0
    s_branch L_goy
L_go:
    s_waitcnt vmcnt(4)
    v_mfma_f32_16x16x32_bf16 v[20:23], v[56:59], v[6:9], 0
    v_mfma_f32_16x16x32_bf16 v[24:27], v[60:63], v[6:9], 0
    v_mfma_f32_16x16x32_bf16 v[28:31], v[64:67], v[6:9], 0
    v_mfma_f32_16x16x32_bf16 v[32:35], v[68:71], v[6:9], 0
    buffer_load_dwordx4 v[56:59], v2, s[28:31], s66 offen offset:0 nt
    buffer_load_dwordx4 v[60:63], v2, s[28:31], s66 offen offset:1024 nt
    buffer_load_dwordx4 v[64:67], v2, s[28:31], s66 offen offset:2048 nt
    buffer_load_dwordx4 v[68:71], v2, s[28:31], s66 offen offset:3072 nt
L_goy:
    s_nop 4
    v_cndmask_b32 v44, v20, v25, s[60:61]
    v_cndmask_b32 v45, v24, v29, s[60:61]
    v_cndmask_b32 v46, v28, v33, s[60:61]
    v_cndmask_b32 v47, v32, v21, s[60:61]
    v_cndmask_b32 v44, v44, v30, s[62:63]
    v_cndmask_b32 v45, v45, v34, s[62:63]
    v_cndmask_b32 v46, v46, v22, s[62:63]
    v_cndmask_b32 v47, v47, v26, s[62:63]
    v_cndmask_b32 v45, v45, v23, s[64:65]
    v_cndmask_b32 v46, v46, v27, s[64:65]
    v_cndmask_b32 v47, v47, v31, s[64:65]
    v_cndmask_b32 v44, v44, v35, s[64:65]
    v_add_f32_dpp v44, v45, v44 quad_perm:[3,0,1,2] row_mask:0xf bank_mask:0xf
    v_add_f32_dpp v44, v46, v44 quad_perm:[2,3,0,1] row_mask:0xf bank_mask:0xf
    v_add_f32_dpp v44, v47, v44 quad_perm:[1,2,3,0] row_mask:0xf bank_mask:0xf
    v_cvt_pk_bf16_f32 v44, 0, v44
    v_mul_f32 v44, s74, v44
    v_cvt_pk_bf16_f32 v44, 0, v44
    v_mul_f32 v44, s75, v44
    v_cmp_gt_f32 vcc, v44, v18
    s_cbranch_vccz L_nors
    v_max_f32 v45, v44, v18
    s_nop 1
    v_max_f32_dpp v45, v45, v45 quad_perm:[1,0,3,2] row_mask:0xf bank_mask:0xf
    s_nop 1
    v_max_f32_dpp v45, v45, v45 quad_perm:[2,3,0,1] row_mask:0xf bank_mask:0xf
    v_mov_b32 v46, v45
    s_nop 1
    v_permlane32_swap_b32 v45, v46
    v_max_f32 v45, v45, v46
    v_mov_b32 v46, v45
    s_nop 1
    v_permlane16_swap_b32 v45, v46
    v_max_f32 v45, v45, v46
    v_sub_f32 v46, v18, v45
    v_exp_f32 v46, v46
    v_mov_b32 v18, v45
    v_mul_f32 v19, v19, v46
    v_mov_b32_dpp v47, v46 row_newbcast:0 row_mask:0x1 bank_mask:0xf
    v_mov_b32_dpp v47, v46 row_newbcast:4 row_mask:0x2 bank_mask:0xf
    v_mov_b32_dpp v47, v46 row_newbcast:8 row_mask:0x4 bank_mask:0xf
    v_mov_b32_dpp v47, v46 row_newbcast:12 row_mask:0x8 bank_mask:0xf
    v_mul_f32 v10, v10, v47
    v_mul_f32 v11, v11, v47
    v_mul_f32 v12, v12, v47
    v_mul_f32 v13, v13, v47
    v_mul_f32 v14, v14, v47
    v_mul_f32 v15, v15, v47
    v_mul_f32 v16, v16, v47
    v_mul_f32 v17, v17, v47
L_nors:
    v_sub_f32 v44, v44, v18
    v_exp_f32 v44, v44
    s_nop 0
    v_cvt_pk_bf16_f32 v45, v44, v44
    v_add_f32 v19, v19, v44
    s_nop 0
    v_and_b32_dpp v36, v45, v4 quad_perm:[0,0,0,0] row_mask:0xf bank_mask:0xf
    v_and_b32_dpp v37, v45, v5 quad_perm:[0,0,0,0] row_mask:0xf bank_mask:0xf
    v_and_b32_dpp v38, v45, v4 quad_perm:[1,1,1,1] row_mask:0xf bank_mask:0xf
    v_and_b32_dpp v39, v45, v5 quad_perm:[1,1,1,1] row_mask:0xf bank_mask:0xf
    v_and_b32_dpp v40, v45, v4 quad_perm:[2,2,2,2] row_mask:0xf bank_mask:0xf
    v_and_b32_dpp v41, v45, v5 quad_perm:[2,2,2,2] row_mask:0xf bank_mask:0xf
    v_and_b32_dpp v42, v45, v4 quad_perm:[3,3,3,3] row_mask:0xf bank_mask:0xf
    v_and_b32_dpp v43, v45, v5 quad_perm:[3,3,3,3] row_mask:0xf bank_mask:0xf
    s_cmp_ge_u32 s66, s30
    s_cbranch_scc1 L_last
    s_waitcnt vmcnt(4)
    v_mfma_f32_16x16x16_bf16 v[10:13], v[36:37], v[72:73], v[10:13]
    v_mfma_f32_16x16x16_bf16 v[14:17], v[36:37], v[74:75], v[14:17]
    v_mfma_f32_16x16x16_bf16 v[10:13], v[38:39], v[76:77], v[10:13]
    v_mfma_f32_16x16x16_bf16 v[14:17], v[38:39], v[78:79], v[14:17]
    v_mfma_f32_16x16x16_bf16 v[10:13], v[40:41], v[80:81], v[10:13]
    v_mfma_f32_16x16x16_bf16 v[14:17], v[40:41], v[82:83], v[14:17]
    v_mfma_f32_16x16x16_bf16 v[10:13], v[42:43], v[84:85], v[10:13]
    v_mfma_f32_16x16x16_bf16 v[14:17], v[42:43], v[86:87], v[14:17]
    buffer_load_dwordx4 v[72:75], v3, s[32:35], s66 offen offset:0 nt
    buffer_load_dwordx4 v[76:79], v3, s[32:35], s66 offen offset:1024 nt
    buffer_load_dwordx4 v[80:83], v3, s[32:35], s66 offen offset:2048 nt
    buffer_load_dwordx4 v[84:87], v3, s[32:35], s66 offen offset:3072 nt
    s_branch L_loop
L_first:
    s_mov_b32 s69, 0
    s_cmp_eq_u32 s3, 0
    s_cbranch_scc1 L_setup
    s_waitcnt vmcnt(8)
    v_mfma_f32_16x16x32_bf16 v[20:23], v[88:91], v[6:9], 0
    v_mfma_f32_16x16x32_bf16 v[24:27], v[92:95], v[6:9], 0
    v_mfma_f32_16x16x32_bf16 v[28:31], v[96:99], v[6:9], 0
    v_mfma_f32_16x16x32_bf16 v[32:35], v[100:103], v[6:9], 0
    s_nop 5
    v_cndmask_b32 v44, v20, v25, s[60:61]
    v_cndmask_b32 v45, v24, v29, s[60:61]
    v_cndmask_b32 v46, v28, v33, s[60:61]
    v_cndmask_b32 v47, v32, v21, s[60:61]
    v_cndmask_b32 v44, v44, v30, s[62:63]
    v_cndmask_b32 v45, v45, v34, s[62:63]
    v_cndmask_b32 v46, v46, v22, s[62:63]
    v_cndmask_b32 v47, v47, v26, s[62:63]
    v_cndmask_b32 v45, v45, v23, s[64:65]
    v_cndmask_b32 v46, v46, v27, s[64:65]
    v_cndmask_b32 v47, v47, v31, s[64:65]
    v_cndmask_b32 v44, v44, v35, s[64:65]
    v_add_f32_dpp v44, v45, v44 quad_perm:[3,0,1,2] row_mask:0xf bank_mask:0xf
    v_add_f32_dpp v44, v46, v44 quad_perm:[2,3,0,1] row_mask:0xf bank_mask:0xf
    v_add_f32_dpp v44, v47, v44 quad_perm:[1,2,3,0] row_mask:0xf bank_mask:0xf
    v_cvt_pk_bf16_f32 v44, 0, v44
    v_mul_f32 v44, s74, v44
    v_cvt_pk_bf16_f32 v44, 0, v44
    v_mul_f32 v44, s75, v44
    ds_write_b32 v48, v44 offset:3584
    v_max_f32 v18, v18, v44
    v_mfma_f32_16x16x32_bf16 v[20:23], v[104:107], v[6:9], 0
    v_mfma_f32_16x16x32_bf16 v[24:27], v[108:111], v[6:9], 0
    v_mfma_f32_16x16x32_bf16 v[28:31], v[112:115], v[6:9], 0
    v_mfma_f32_16x16x32_bf16 v[32:35], v[116:119], v[6:9], 0
    s_nop 5
    v_cndmask_b32 v44, v20, v25, s[60:61]
    v_cndmask_b32 v45, v24, v29, s[60:61]
    v_cndmask_b32 v46, v28, v33, s[60:61]
    v_cndmask_b32 v47, v32, v21, s[60:61]
    v_cndmask_b32 v44, v44, v30, s[62:63]
    v_cndmask_b32 v45, v45, v34, s[62:63]
    v_cndmask_b32 v46, v46, v22, s[62:63]
    v_cndmask_b32 v47, v47, v26, s[62:63]
    v_cndmask_b32 v45, v45, v23, s[64:65]
    v_cndmask_b32 v46, v46, v27, s[64:65]
    v_cndmask_b32 v47, v47, v31, s[64:65]
    v_cndmask_b32 v44, v44, v35, s[64:65]
    v_add_f32_dpp v44, v45, v44 quad_perm:[3,0,1,2] row_mask:0xf bank_mask:0xf
    v_add_f32_dpp v44, v46, v44 quad_perm:[2,3,0,1] row_mask:0xf bank_mask:0xf
    v_add_f32_dpp v44, v47, v44 quad_perm:[1,2,3,0] row_mask:0xf bank_mask:0xf
    v_cvt_pk_bf16_f32 v44, 0, v44
    v_mul_f32 v44, s74, v44
    v_cvt_pk_bf16_f32 v44, 0, v44
    v_mul_f32 v44, s75, v44
    ds_write_b32 v48, v44 offset:3840
    v_max_f32 v18, v18, v44
    s_and_b32 s71, s2, 7
    s_cbranch_scc0 L_setup
    v_mfma_f32_16x16x32_bf16 v[20:23], v[120:123], v[6:9], 0
    v_mfma_f32_16x16x32_bf16 v[24:27], v[124:127], v[6:9], 0
    v_mfma_f32_16x16x32_bf16 v[28:31], v[128:131], v[6:9], 0
    v_mfma_f32_16x16x32_bf16 v[32:35], v[132:135], v[6:9], 0
    s_nop 5
    v_cndmask_b32 v44, v20, v25, s[60:61]
    v_cndmask_b32 v45, v24, v29, s[60:61]
    v_cndmask_b32 v46, v28, v33, s[60:61]
    v_cndmask_b32 v47, v32, v21, s[60:61]
    v_cndmask_b32 v44, v44, v30, s[62:63]
    v_cndmask_b32 v45, v45, v34, s[62:63]
    v_cndmask_b32 v46, v46, v22, s[62:63]
    v_cndmask_b32 v47, v47, v26, s[62:63]
    v_cndmask_b32 v45, v45, v23, s[64:65]
    v_cndmask_b32 v46, v46, v27, s[64:65]
    v_cndmask_b32 v47, v47, v31, s[64:65]
    v_cndmask_b32 v44, v44, v35, s[64:65]
    v_add_f32_dpp v44, v45, v44 quad_perm:[3,0,1,2] row_mask:0xf bank_mask:0xf
    v_add_f32_dpp v44, v46, v44 quad_perm:[2,3,0,1] row_mask:0xf bank_mask:0xf
    v_add_f32_dpp v44, v47, v44 quad_perm:[1,2,3,0] row_mask:0xf bank_mask:0xf
    v_cvt_pk_bf16_f32 v44, 0, v44
    v_mul_f32 v44, s74, v44
    v_cvt_pk_bf16_f32 v44, 0, v44
    v_mul_f32 v44, s75, v44
    ds_write_b32 v48, v44 offset:7168
    v_max_f32 v18, v18, v44
    v_mfma_f32_16x16x32_bf16 v[20:23], v[136:139], v[6:9], 0
    v_mfma_f32_16x16x32_bf16 v[24:27], v[140:143], v[6:9], 0
    v_mfma_f32_16x16x32_bf16 v[28:31], v[144:147], v[6:9], 0
    v_mfma_f32_16x16x32_bf16 v[32:35], v[148:151], v[6:9], 0
    s_nop 5
    v_cndmask_b32 v44, v20, v25, s[60:61]
    v_cndmask_b32 v45, v24, v29, s[60:61]
    v_cndmask_b32 v46, v28, v33, s[60:61]
    v_cndmask_b32 v47, v32, v21, s[60:61]
    v_cndmask_b32 v44, v44, v30, s[62:63]
    v_cndmask_b32 v45, v45, v34, s[62:63]
    v_cndmask_b32 v46, v46, v22, s[62:63]
    v_cndmask_b32 v47, v47, v26, s[62:63]
    v_cndmask_b32 v45, v45, v23, s[64:65]
    v_cndmask_b32 v46, v46, v27, s[64:65]
    v_cndmask_b32 v47, v47, v31, s[64:65]
    v_cndmask_b32 v44, v44, v35, s[64:65]
    v_add_f32_dpp v44, v45, v44 quad_perm:[3,0,1,2] row_mask:0xf bank_mask:0xf
    v_add_f32_dpp v44, v46, v44 quad_perm:[2,3,0,1] row_mask:0xf bank_mask:0xf
    v_add_f32_dpp v44, v47, v44 quad_perm:[1,2,3,0] row_mask:0xf bank_mask:0xf
    v_cvt_pk_bf16_f32 v44, 0, v44
    v_mul_f32 v44, s74, v44
    v_cvt_pk_bf16_f32 v44, 0, v44
    v_mul_f32 v44, s75, v44
    ds_write_b32 v48, v44 offset:7424
    v_max_f32 v18, v18, v44
    v_mfma_f32_16x16x32_bf16 v[20:23], v[152:155], v[6:9], 0
    v_mfma_f32_16x16x32_bf16 v[24:27], v[156:159], v[6:9], 0
    v_mfma_f32_16x16x32_bf16 v[28:31], v[160:163], v[6:9], 0
    v_mfma_f32_16x16x32_bf16 v[32:35], v[164:167], v[6:9], 0
    s_nop 5
    v_cndmask_b32 v44, v20, v25, s[60:61]
    v_cndmask_b32 v45, v24, v29, s[60:61]
    v_cndmask_b32 v46, v28, v33, s[60:61]
    v_cndmask_b32 v47, v32, v21, s[60:61]
    v_cndmask_b32 v44, v44, v30, s[62:63]
    v_cndmask_b32 v45, v45, v34, s[62:63]
    v_cndmask_b32 v46, v46, v22, s[62:63]
    v_cndmask_b32 v47, v47, v26, s[62:63]
    v_cndmask_b32 v45, v45, v23, s[64:65]
    v_cndmask_b32 v46, v46, v27, s[64:65]
    v_cndmask_b32 v47, v47, v31, s[64:65]
    v_cndmask_b32 v44, v44, v35, s[64:65]
    v_add_f32_dpp v44, v45, v44 quad_perm:[3,0,1,2] row_mask:0xf bank_mask:0xf
    v_add_f32_dpp v44, v46, v44 quad_perm:[2,3,0,1] row_mask:0xf bank_mask:0xf
    v_add_f32_dpp v44, v47, v44 quad_perm:[1,2,3,0] row_mask:0xf bank_mask:0xf
    v_cvt_pk_bf16_f32 v44, 0, v44
    v_mul_f32 v44, s74, v44
    v_cvt_pk_bf16_f32 v44, 0, v44
    v_mul_f32 v44, s75, v44
    ds_write_b32 v48, v44 offset:10752
    v_max_f32 v18, v18, v44
    v_mfma_f32_16x16x32_bf16 v[20:23], v[168:171], v[6:9], 0
    v_mfma_f32_16x16x32_bf16 v[24:27], v[172:175], v[6:9], 0
    v_mfma_f32_16x16x32_bf16 v[28:31], v[176:179], v[6:9], 0
    v_mfma_f32_16x16x32_bf16 v[32:35], v[180:183], v[6:9], 0
    s_nop 5
    v_cndmask_b32 v44, v20, v25, s[60:61]
    v_cndmask_b32 v45, v24, v29, s[60:61]
    v_cndmask_b32 v46, v28, v33, s[60:61]
    v_cndmask_b32 v47, v32, v21, s[60:61]
    v_cndmask_b32 v44, v44, v30, s[62:63]
    v_cndmask_b32 v45, v45, v34, s[62:63]
    v_cndmask_b32 v46, v46, v22, s[62:63]
    v_cndmask_b32 v47, v47, v26, s[62:63]
    v_cndmask_b32 v45, v45, v23, s[64:65]
    v_cndmask_b32 v46, v46, v27, s[64:65]
    v_cndmask_b32 v47, v47, v31, s[64:65]
    v_cndmask_b32 v44, v44, v35, s[64:65]
    v_add_f32_dpp v44, v45, v44 quad_perm:[3,0,1,2] row_mask:0xf bank_mask:0xf
    v_add_f32_dpp v44, v46, v44 quad_perm:[2,3,0,1] row_mask:0xf bank_mask:0xf
    v_add_f32_dpp v44, v47, v44 quad_perm:[1,2,3,0] row_mask:0xf bank_mask:0xf
    v_cvt_pk_bf16_f32 v44, 0, v44
    v_mul_f32 v44, s74, v44
    v_cvt_pk_bf16_f32 v44, 0, v44
    v_mul_f32 v44, s75, v44
    ds_write_b32 v48, v44 offset:11008
    v_max_f32 v18, v18, v44
    v_mfma_f32_16x16x32_bf16 v[20:23], v[184:187], v[6:9], 0
    v_mfma_f32_16x16x32_bf16 v[24:27], v[188:191], v[6:9], 0
    v_mfma_f32_16x16x32_bf16 v[28:31], v[192:195], v[6:9], 0
    v_mfma_f32_16x16x32_bf16 v[32:35], v[196:199], v[6:9], 0
    s_nop 5
    v_cndmask_b32 v44, v20, v25, s[60:61]
    v_cndmask_b32 v45, v24, v29, s[60:61]
    v_cndmask_b32 v46, v28, v33, s[60:61]
    v_cndmask_b32 v47, v32, v21, s[60:61]
    v_cndmask_b32 v44, v44, v30, s[62:63]
    v_cndmask_b32 v45, v45, v34, s[62:63]
    v_cndmask_b32 v46, v46, v22, s[62:63]
    v_cndmask_b32 v47, v47, v26, s[62:63]
    v_cndmask_b32 v45, v45, v23, s[64:65]
    v_cndmask_b32 v46, v46, v27, s[64:65]
    v_cndmask_b32 v47, v47, v31, s[64:65]
    v_cndmask_b32 v44, v44, v35, s[64:65]
    v_add_f32_dpp v44, v45, v44 quad_perm:[3,0,1,2] row_mask:0xf bank_mask:0xf
    v_add_f32_dpp v44, v46, v44 quad_perm:[2,3,0,1] row_mask:0xf bank_mask:0xf
    v_add_f32_dpp v44, v47, v44 quad_perm:[1,2,3,0] row_mask:0xf bank_mask:0xf
    v_cvt_pk_bf16_f32 v44, 0, v44
    v_mul_f32 v44, s74, v44
    v_cvt_pk_bf16_f32 v44, 0, v44
    v_mul_f32 v44, s75, v44
    ds_write_b32 v48, v44 offset:14336
    v_max_f32 v18, v18, v44
    v_mfma_f32_16x16x32_bf16 v[20:23], v[200:203], v[6:9], 0
    v_mfma_f32_16x16x32_bf16 v[24:27], v[204:207], v[6:9], 0
    v_mfma_f32_16x16x32_bf16 v[28:31], v[208:211], v[6:9], 0
    v_mfma_f32_16x16x32_bf16 v[32:35], v[212:215], v[6:9], 0
    s_nop 5
    v_cndmask_b32 v44, v20, v25, s[60:61]
    v_cndmask_b32 v45, v24, v29, s[60:61]
    v_cndmask_b32 v46, v28, v33, s[60:61]
    v_cndmask_b32 v47, v32, v21, s[60:61]
    v_cndmask_b32 v44, v44, v30, s[62:63]
    v_cndmask_b32 v45, v45, v34, s[62:63]
    v_cndmask_b32 v46, v46, v22, s[62:63]
    v_cndmask_b32 v47, v47, v26, s[62:63]
    v_cndmask_b32 v45, v45, v23, s[64:65]
    v_cndmask_b32 v46, v46, v27, s[64:65]
    v_cndmask_b32 v47, v47, v31, s[64:65]
    v_cndmask_b32 v44, v44, v35, s[64:65]
    v_add_f32_dpp v44, v45, v44 quad_perm:[3,0,1,2] row_mask:0xf bank_mask:0xf
    v_add_f32_dpp v44, v46, v44 quad_perm:[2,3,0,1] row_mask:0xf bank_mask:0xf
    v_add_f32_dpp v44, v47, v44 quad_perm:[1,2,3,0] row_mask:0xf bank_mask:0xf
    v_cvt_pk_bf16_f32 v44, 0, v44
    v_mul_f32 v44, s74, v44
    v_cvt_pk_bf16_f32 v44, 0, v44
    v_mul_f32 v44, s75, v44
    ds_write_b32 v48, v44 offset:14592
    v_max_f32 v18, v18, v44
L_setup:
    v_lshrrev_b32 v46, 4, v1
    v_and_b32 v47, 3, v1
    v_bfe_u32 v45, v1, 2, 2
    v_and_b32 v50, 15, v1
    v_and_b32 v48, 1, v46
    v_lshlrev_b32 v48, 1, v48
    v_lshrrev_b32 v49, 1, v46
    v_or_b32 v48, v48, v49
    s_lshl_b32 s71, s3, 11
    v_lshlrev_b32 v216, 5, v1
    v_add_u32 v216, s71, v216
    s_lshl_b32 s71, s3, 3
    v_lshlrev_b32 v217, 6, v45
    v_add_u32 v217, s71, v217
    v_lshrrev_b32 v218, 1, v217
    s_lshl_b32 s71, s3, 8
    v_lshlrev_b32 v219, 12, v46
    v_lshl_add_u32 v219, v50, 4, v219
    v_add_u32 v219, s71, v219
    s_lshr_b32 s71, s3, 1
    s_lshl_b32 s73, s71, 6
    v_lshlrev_b32 v220, 4, v46
    v_add_u32 v220, s73, v220
    s_lshl_b32 s73, s71, 5
    v_mov_b32 v221, s73
    v_lshl_add_u32 v222, v50, 2, v48
    v_lshlrev_b32 v222, 1, v222
    s_lshl_b32 s0, s76, 15
    s_lshl_b32 s73, s79, 10
    s_add_u32 s0, s0, s73
    s_lshl_b32 s73, s3, 7
    s_add_u32 s0, s0, s73
    s_add_u32 s0, s0, 65536
    s_lshr_b32 s73, s3, 1
    s_lshl2_add_u32 s1, s76, s73
    s_lshl_b32 s1, s1, 5
    s_add_u32 s1, s1, s79
    s_lshl_b32 s1, s1, 5
    s_add_u32 s1, s1, 1310720
    v_lshlrev_b32 v226, 1, v1
    s_and_b32 s71, s2, 7
    s_cbranch_scc1 L_kn
    s_mov_b32 s69, 2
    s_getreg_b32 s78, hwreg(HW_REG_XCC_ID, 0, 4)
    s_lshl_b32 s78, s78, 8
    s_cmp_lg_u32 s3, 0
    s_cbranch_scc1 L_nox
    v_mov_b32 v24, -1
    v_mov_b32 v25, -1
    v_mov_b32 v26, -1
    v_mov_b32 v27, -1
    s_cmp_ge_u32 s77, 28
    s_cselect_b32 s71, 0, -1
    v_mov_b32 v28, s71
    v_mov_b32 v29, s71
    v_mov_b32 v30, s71
    v_mov_b32 v31, s71
    s_lshl_b32 s71, s77, 11
    s_add_u32 s71, s71, 720896
    buffer_store_dwordx4 v[28:31], v3, s[36:39], s71 offen sc1
    buffer_store_dwordx4 v[28:31], v3, s[36:39], s71 offen offset:1024 sc1
    s_lshl_b32 s71, s77, 9
    s_add_u32 s71, s71, 704512
    s_mov_b32 exec_hi, 0
    buffer_store_dwordx4 v[24:27], v3, s[36:39], s71 offen sc1
    s_mov_b32 exec_hi, -1
    s_waitcnt vmcnt(0)
    s_or_b32 s71, s78, s53
    v_mov_b32 v20, s71
    v_mov_b32 v21, s54
    v_mov_b32 v22, s55
    v_mov_b32 v23, s56
    s_lshl_b32 s71, s77, 4
    s_add_u32 s71, s71, 2048
    s_mov_b64 exec, 1
    buffer_store_dwordx4 v[20:23], v3, s[36:39], s71 offen sc1
    s_mov_b64 exec, -1
L_nox:
    s_mov_b32 s40, s12
    s_mov_b32 s41, s13
    s_mov_b32 s42, 0x400000
    s_mov_b32 s43, 0x20000
    s_lshr_b32 s68, s77, 1
    s_lshl_b32 s71, s68, 18
    s_lshr_b32 s73, s3, 1
    s_lshl_b32 s73, s73, 16
    s_add_u32 s71, s71, s73
    s_and_b32 s73, s3, 1
    s_lshl_b32 s73, s73, 10
    s_add_u32 s71, s71, s73
    s_and_b32 s73, s77, 1
    s_lshl_b32 s73, s73, 9
    s_add_u32 s71, s71, s73
    v_and_b32 v45, 1, v46
    v_lshlrev_b32 v45, 15, v45
    v_lshl_add_u32 v45, v49, 13, v45
    v_lshlrev_b32 v44, 4, v50
    v_add_u32 v45, v45, v44
    v_lshl_add_u32 v44, v48, 11, v44
    buffer_load_dwordx4 v[88:91], v45, s[40:43], s71 offen offset:0 nt
    buffer_load_dwordx4 v[120:123], v45, s[40:43], s71 offen offset:256 nt
    buffer_load_dwordx4 v[96:99], v45, s[40:43], s71 offen offset:2048 nt
    buffer_load_dwordx4 v[128:131], v45, s[40:43], s71 offen offset:2304 nt
    s_add_u32 s71, s71, 4096
    buffer_load_dwordx4 v[92:95], v45, s[40:43], s71 offen offset:0 nt
    buffer_load_dwordx4 v[124:127], v45, s[40:43], s71 offen offset:256 nt
    buffer_load_dwordx4 v[100:103], v45, s[40:43], s71 offen offset:2048 nt
    buffer_load_dwordx4 v[132:135], v45, s[40:43], s71 offen offset:2304 nt
    s_add_u32 s71, s71, 12288
    buffer_load_dwordx4 v[104:107], v45, s[40:43], s71 offen offset:0 nt
    buffer_load_dwordx4 v[136:139], v45, s[40:43], s71 offen offset:256 nt
    buffer_load_dwordx4 v[112:115], v45, s[40:43], s71 offen offset:2048 nt
    buffer_load_dwordx4 v[144:147], v45, s[40:43], s71 offen offset:2304 nt
    s_add_u32 s71, s71, 4096
    buffer_load_dwordx4 v[108:111], v45, s[40:43], s71 offen offset:0 nt
    buffer_load_dwordx4 v[140:143], v45, s[40:43], s71 offen offset:256 nt
    buffer_load_dwordx4 v[116:119], v45, s[40:43], s71 offen offset:2048 nt
    buffer_load_dwordx4 v[148:151], v45, s[40:43], s71 offen offset:2304 nt
    v_and_b32 v51, 7, v1
    v_bfe_u32 v49, v1, 3, 1
    v_lshl_add_u32 v241, v48, 1, v49
    v_lshl_add_u32 v241, v51, 3, v241
    s_lshl_b32 s71, s3, 6
    v_add_lshl_u32 v241, v241, s71, 1
    buffer_load_ushort v229, v241, s[48:51], 0 offen
    v_and_b32 v51, 7, v1
    v_and_b32 v45, 1, v46
    v_lshrrev_b32 v49, 5, v1
    v_lshrrev_b32 v225, 2, v1
    v_lshlrev_b32 v224, 11, v225
    v_lshl_add_u32 v224, v47, 4, v224
    v_and_b32 v223, 1, v1
    v_lshl_add_u32 v225, v225, 1, v223
    v_lshlrev_b32 v225, 5, v225
    v_lshlrev_b32 v240, 4, v45
    v_lshl_add_u32 v240, v50, 5, v240
    v_lshl_add_u32 v227, v49, 9, v240
    s_lshl_b32 s71, s3, 10
    v_add_u32 v227, s71, v227
    v_lshrrev_b32 v240, 1, v240
    v_lshrrev_b32 v230, 3, v1
    v_lshlrev_b32 v230, 10, v230
    v_lshl_add_u32 v230, v51, 4, v230
    v_lshrrev_b32 v228, 3, v1
    v_lshlrev_b32 v228, 10, v228
    v_lshl_add_u32 v228, v51, 4, v228
    s_lshl_b32 s71, s3, 7
    v_add_u32 v228, s71, v228
    s_lshl_b32 s71, s3, 4
    v_lshlrev_b32 v236, 3, v49
    v_add_u32 v236, s71, v236
    v_lshlrev_b32 v237, 4, v51
    v_bfe_u32 v49, v1, 3, 1
    v_lshlrev_b32 v239, 11, v46
    v_lshl_add_u32 v239, v49, 8, v239
    v_lshl_add_u32 v239, v51, 4, v239
    s_lshr_b32 s71, s3, 2
    s_lshl_b32 s71, s71, 7
    v_add_u32 v239, s71, v239
    s_lshl_b32 s71, s3, 13
    s_add_u32 s71, s71, 38912
    v_add_u32 v242, s71, v3
    s_mov_b32 m0, s71
    v_lshrrev_b32 v238, 1, v1
    v_lshlrev_b32 v238, 10, v238
    v_and_b32 v45, 1, v1
    v_lshl_add_u32 v238, v45, 4, v238
    s_mov_b32 s44, s22
    s_mov_b32 s45, s23
    s_mov_b32 s46, 0x400
    s_mov_b32 s47, 0x20000
    s_cmp_ge_u32 s77, 28
    s_cbranch_scc1 L_suj
    s_mov_b32 s69, 1
    s_lshl_b32 s71, s3, 6
    v_lshl_add_u32 v45, v48, 2, s71
    v_mul_u32_u24 v45, 3584, v45
    v_lshl_add_u32 v45, v51, 4, v45
    s_lshl_b32 s71, s77, 7
    v_add_u32 v45, s71, v45
    v_cmp_eq_u32 vcc, 0, v49
    v_mov_b32 v20, s16
    v_mov_b32 v21, s18
    v_cndmask_b32 v20, v21, v20, vcc
    v_mov_b32 v21, s17
    v_mov_b32 v22, s19
    v_cndmask_b32 v21, v22, v21, vcc
    v_add_co_u32 v20, vcc, v20, v45
    s_nop 1
    v_addc_co_u32 v21, vcc, 0, v21, vcc
    s_mov_b32 s40, s20
    s_mov_b32 s41, s21
    s_mov_b32 s42, 0x1c0000
    s_mov_b32 s43, 0x20000
    s_lshl_b32 s71, s77, 16
    s_lshr_b32 s73, s3, 2
    s_lshl_b32 s73, s73, 15
    s_add_u32 s71, s71, s73
    s_and_b32 s73, s3, 3
    s_lshl_b32 s73, s73, 8
    s_add_u32 s71, s71, s73
    buffer_load_dwordx4 v44, s[40:43], s71 offen nt lds
    s_add_u32 s71, s71, 1024
    s_add_u32 m0, m0, 1024
    s_nop 0
    buffer_load_dwordx4 v44, s[40:43], s71 offen nt lds
    s_add_u32 s71, s71, 7168
    s_add_u32 m0, m0, 1024
    s_nop 0
    buffer_load_dwordx4 v44, s[40:43], s71 offen nt lds
    s_add_u32 s71, s71, 1024
    s_add_u32 m0, m0, 1024
    s_nop 0
    buffer_load_dwordx4 v44, s[40:43], s71 offen nt lds
    s_add_u32 s71, s71, 7168
    s_add_u32 m0, m0, 1024
    s_nop 0
    buffer_load_dwordx4 v44, s[40:43], s71 offen nt lds
    s_add_u32 s71, s71, 1024
    s_add_u32 m0, m0, 1024
    s_nop 0
    buffer_load_dwordx4 v44, s[40:43], s71 offen nt lds
    s_add_u32 s71, s71, 7168
    s_add_u32 m0, m0, 1024
    s_nop 0
    buffer_load_dwordx4 v44, s[40:43], s71 offen nt lds
    s_add_u32 s71, s71, 1024
    s_add_u32 m0, m0, 1024
    s_nop 0
    buffer_load_dwordx4 v44, s[40:43], s71 offen nt lds
    global_load_dwordx4 v[152:155], v[20:21], off offset:0 nt
    global_load_dwordx4 v[184:187], v[20:21], off offset:3584 nt
    v_add_co_u32 v20, vcc, 7168, v20
    s_nop 1
    v_addc_co_u32 v21, vcc, 0, v21, vcc
    global_load_dwordx4 v[156:159], v[20:21], off offset:0 nt
    global_load_dwordx4 v[188:191], v[20:21], off offset:3584 nt
    v_add_co_u32 v20, vcc, 50176, v20
    s_nop 1
    v_addc_co_u32 v21, vcc, 0, v21, vcc
    global_load_dwordx4 v[160:163], v[20:21], off offset:0 nt
    global_load_dwordx4 v[192:195], v[20:21], off offset:3584 nt
    v_add_co_u32 v20, vcc, 7168, v20
    s_nop 1
    v_addc_co_u32 v21, vcc, 0, v21, vcc
    global_load_dwordx4 v[164:167], v[20:21], off offset:0 nt
    global_load_dwordx4 v[196:199], v[20:21], off offset:3584 nt
    v_add_co_u32 v20, vcc, 50176, v20
    s_nop 1
    v_addc_co_u32 v21, vcc, 0, v21, vcc
    global_load_dwordx4 v[168:171], v[20:21], off offset:0 nt
    global_load_dwordx4 v[200:203], v[20:21], off offset:3584 nt
    v_add_co_u32 v20, vcc, 7168, v20
    s_nop 1
    v_addc_co_u32 v21, vcc, 0, v21, vcc
    global_load_dwordx4 v[172:175], v[20:21], off offset:0 nt
    global_load_dwordx4 v[204:207], v[20:21], off offset:3584 nt
    v_add_co_u32 v20, vcc, 50176, v20
    s_nop 1
    v_addc_co_u32 v21, vcc, 0, v21, vcc
    global_load_dwordx4 v[176:179], v[20:21], off offset:0 nt
    global_load_dwordx4 v[208:211], v[20:21], off offset:3584 nt
    v_add_co_u32 v20, vcc, 7168, v20
    s_nop 1
    v_addc_co_u32 v21, vcc, 0, v21, vcc
    global_load_dwordx4 v[180:183], v[20:21], off offset:0 nt
    global_load_dwordx4 v[212:215], v[20:21], off offset:3584 nt
L_suj:
    s_lshl_b32 s22, s77, 5
    s_add_u32 s22, s22, 720896
    s_add_u32 s23, s22, 32768
    s_lshl_b32 s24, s3, 7
    s_add_u32 s24, s24, 704512
    s_add_u32 s25, s24, 8192
    s_lshr_b32 s16, s68, 1
    s_lshl_b32 s16, s16, 15
    s_and_b32 s71, s68, 1
    s_lshl_b32 s71, s71, 9
    s_add_u32 s16, s16, s71
    s_lshl_b32 s71, s3, 6
    s_add_u32 s16, s16, s71
    s_add_u32 s16, s16, 65536
    s_lshr_b32 s71, s3, 2
    s_lshl1_add_u32 s20, s68, s71
    s_lshl_b32 s20, s20, 10
    s_add_u32 s20, s20, 1310720
    s_lshl_b32 s21, s77, 9
    s_lshl_b32 s73, s3, 6
    s_add_u32 s21, s21, s73
    s_add_u32 s21, s21, 704512
    s_lshl_b32 s18, s77, 11
    s_lshl_b32 s71, s3, 8
    s_add_u32 s18, s18, s71
    s_add_u32 s18, s18, 720896
    s_lshr_b32 s68, s77, 2
    s_branch L_kn
L_dyn:
    s_sub_u32 s73, s71, s10
    s_lshr_b32 s73, s73, 11
    v_mov_b32 v48, s73
L_dynw:
    ds_read_b32 v49, v48 offset:36864
    s_waitcnt lgkmcnt(0)
    v_readfirstlane_b32 s66, v49
    s_nop 0
    s_cmp_lg_u32 s66, -1
    s_cbranch_scc1 L_dyng
    s_sub_u32 s72, s72, 1
    s_cbranch_scc1 L_end
    s_branch L_dynw
L_dyng:
    s_cmp_ge_u32 s66, s30
    s_cbranch_scc1 L_dretx
    s_bitcmp1_b32 s66, 0
    s_cbranch_scc0 L_dret
    s_and_b32 s66, s66, -2
    s_max_u32 s71, s66, s57
    s_sub_u32 s71, s71, s57
    s_lshr_b32 s71, s71, 12
    s_sub_u32 s71, s67, s71
    s_and_b32 s14, s2, 7
    s_cselect_b32 s14, 0, 64
    s_cmp_gt_u32 s71, s14
    s_cbranch_scc1 L_dynt
    v_lshl_add_u32 v48, v1, 2, v48
    v_mov_b32 v51, s30
    ds_write_b32 v48, v51 offset:36872
    s_branch L_dret
L_dynt:
    s_cmp_gt_u32 s71, 48
    s_cselect_b32 s15, 4, 2
    s_cmp_gt_u32 s71, 128
    s_cselect_b32 s15, 8, s15
    s_mov_b32 s14, s15
    s_atomic_add s14, s[26:27], s58 glc
    v_lshl_add_u32 v48, v1, 2, v48
    s_sub_u32 s73, s15, 2
    s_waitcnt lgkmcnt(0)
    v_add_u32 v49, s14, v1
    v_lshlrev_b32 v50, 12, v49
    v_add_u32 v50, s57, v50
    s_add_u32 s14, s14, s15
    s_cmp_ge_u32 s14, s67
    s_cbranch_scc1 L_dynx
    v_cmp_eq_u32 vcc, s73, v1
    s_nop 1
    v_addc_co_u32 v50, vcc, 0, v50, vcc
    v_cmp_gt_u32 vcc, s15, v1
    s_nop 0
    s_mov_b64 exec, vcc
    ds_write_b32 v48, v50 offset:36872
    s_mov_b64 exec, -1
    s_branch L_dret
L_dynx:
    v_mov_b32 v51, s30
    v_cmp_gt_u32 vcc, s67, v49
    s_nop 1
    v_cndmask_b32 v50, v51, v50, vcc
    ds_write_b32 v48, v50 offset:36872
    s_branch L_dret
L_dret:
    s_cmp_eq_u32 s11, 3
    s_cbranch_scc1 L_go
    s_branch L_vc0
L_dretx:
    s_cmp_eq_u32 s11, 3
    s_cbranch_scc1 L_gox
    s_branch L_vc0
L_done:
    v_add_f32_dpp v19, v19, v19 quad_perm:[1,0,3,2] row_mask:0xf bank_mask:0xf
    s_nop 1
    v_add_f32_dpp v19, v19, v19 quad_perm:[2,3,0,1] row_mask:0xf bank_mask:0xf
    ds_write_b32 v218, v18 offset:16640
    v_mov_b32 v49, v19
    s_nop 1
    v_permlane32_swap_b32 v19, v49
    v_add_f32 v19, v19, v49
    v_mov_b32 v49, v19
    s_nop 1
    v_permlane16_swap_b32 v19, v49
    v_add_f32 v19, v19, v49
    ds_write_b64 v217, v[18:19] offset:16384
    s_branch L_done2
L_last:
    v_add_f32_dpp v19, v19, v19 quad_perm:[1,0,3,2] row_mask:0xf bank_mask:0xf
    s_nop 1
    v_add_f32_dpp v19, v19, v19 quad_perm:[2,3,0,1] row_mask:0xf bank_mask:0xf
    ds_write_b32 v218, v18 offset:16640
    v_mov_b32 v49, v19
    s_nop 1
    v_permlane32_swap_b32 v19, v49
    v_add_f32 v19, v19, v49
    v_mov_b32 v49, v19
    s_nop 1
    v_permlane16_swap_b32 v19, v49
    v_add_f32 v19, v19, v49
    ds_write_b64 v217, v[18:19] offset:16384
    s_waitcnt vmcnt(0)
    v_mfma_f32_16x16x16_bf16 v[10:13], v[36:37], v[72:73], v[10:13]
    v_mfma_f32_16x16x16_bf16 v[14:17], v[36:37], v[74:75], v[14:17]
    v_mfma_f32_16x16x16_bf16 v[10:13], v[38:39], v[76:77], v[10:13]
    v_mfma_f32_16x16x16_bf16 v[14:17], v[38:39], v[78:79], v[14:17]
    v_mfma_f32_16x16x16_bf16 v[10:13], v[40:41], v[80:81], v[10:13]
    v_mfma_f32_16x16x16_bf16 v[14:17], v[40:41], v[82:83], v[14:17]
    v_mfma_f32_16x16x16_bf16 v[10:13], v[42:43], v[84:85], v[10:13]
    v_mfma_f32_16x16x16_bf16 v[14:17], v[42:43], v[86:87], v[14:17]
L_done2:
    s_mov_b32 s73, 0xffffff00
    s_mov_b32 s60, 0xfffefffe
    v_mov_b32 v47, s53
    v_mov_b32 v48, s54
    v_mov_b32 v39, s56
    s_nop 1
    ds_write_b128 v216, v[10:13] offset:0
    ds_write_b128 v216, v[14:17] offset:16
    s_cmp_eq_u32 s69, 1
    s_cbranch_scc1 L_cs
L_csr:
    s_waitcnt lgkmcnt(0)
    s_barrier
    ds_read_b128 v[20:23], v221 offset:16640
    ds_read_b128 v[24:27], v221 offset:16656
    ds_read_b128 v[28:31], v220 offset:16384
    ds_read_b128 v[10:13], v219 offset:0
    ds_read_b128 v[14:17], v219 offset:2048
    s_waitcnt lgkmcnt(3)
    v_max3_f32 v36, v20, v21, v22
    v_max3_f32 v37, v23, v24, v25
    v_max3_f32 v36, v36, v26, v27
    v_max_f32 v36, v36, v37
    s_waitcnt lgkmcnt(2)
    v_sub_f32 v28, v28, v36
    v_sub_f32 v30, v30, v36
    v_exp_f32 v28, v28
    v_exp_f32 v30, v30
    v_lshl_or_b32 v38, v36, 24, s55
    v_mul_f32 v37, v28, v29
    v_fmac_f32 v37, v30, v31
    s_waitcnt lgkmcnt(0)
    v_mov_b32 v49, v37
    v_mul_f32 v10, v10, v28
    v_mul_f32 v11, v11, v28
    v_mul_f32 v12, v12, v28
    v_mul_f32 v13, v13, v28
    v_permlane32_swap_b32 v37, v49
    v_fmac_f32 v10, v14, v30
    v_fmac_f32 v11, v15, v30
    v_add_f32 v37, v37, v49
    v_fmac_f32 v12, v16, v30
    v_fmac_f32 v13, v17, v30
    v_mov_b32 v49, v37
    v_permlane32_swap_b32 v10, v11
    v_permlane32_swap_b32 v12, v13
    v_add_f32 v10, v10, v11
    v_add_f32 v12, v12, v13
    v_permlane16_swap_b32 v37, v49
    v_add_f32 v37, v37, v49
    v_permlane16_swap_b32 v10, v12
    v_add_f32 v10, v10, v12
    v_cvt_pk_bf16_f32 v10, 0, v10
    v_min_u32 v10, s60, v10
    buffer_store_short_d16_hi v10, v226, s[36:39], s0 offen sc1
    s_bitcmp1_b32 s3, 0
    s_cbranch_scc1 L_mj
    v_and_or_b32 v37, v37, s73, v48
    v_and_or_b32 v36, v36, s73, v47
    s_mov_b64 exec, 1
    buffer_store_dwordx4 v[36:39], v3, s[36:39], s1 offen sc1
    s_mov_b64 exec, -1
L_mj:
    s_cmp_eq_u32 s69, 0
    s_cbranch_scc1 L_end
    v_and_b32 v54, 0x1f0, v3
    buffer_load_dwordx4 v[40:43], v54, s[36:39], 0 offen offset:2048 sc1
    s_getpc_b64 s[12:13]
L_pcref:
    s_lshl_b32 s71, s3, 9
    s_add_u32 s12, s12, s71
    s_addc_u32 s13, s13, 0
    v_lshlrev_b32 v48, 3, v1
    global_load_dwordx2 v[44:45], v48, s[12:13]
    s_lshl_b32 s71, s3, 5
    s_add_u32 s71, s71, s77
    s_cmp_ge_u32 s71, 80
    s_cbranch_scc1 L_nopt
    s_lshl_b32 s71, s71, 10
    s_add_u32 s71, s71, 704512
    buffer_load_dwordx4 v[44:47], v3, s[36:39], s71 offen sc1
L_nopt:
    ds_read_b128 v[20:23], v239 offset:28672
    ds_read_b128 v[24:27], v239 offset:29184
    ds_read_b128 v[28:31], v239 offset:29696
    ds_read_b128 v[32:35], v239 offset:30208
    s_waitcnt lgkmcnt(0)
    v_pk_add_f32 v[20:21], v[20:21], v[24:25]
    v_pk_add_f32 v[22:23], v[22:23], v[26:27]
    v_pk_add_f32 v[28:29], v[28:29], v[32:33]
    v_pk_add_f32 v[30:31], v[30:31], v[34:35]
    v_pk_add_f32 v[20:21], v[20:21], v[28:29]
    v_pk_add_f32 v[22:23], v[22:23], v[30:31]
    s_nop 0
    v_permlane32_swap_b32 v20, v21
    v_permlane32_swap_b32 v22, v23
    v_add_f32 v20, v20, v21
    v_add_f32 v22, v22, v23
    s_nop 1
    v_permlane16_swap_b32 v20, v22
    v_add_f32 v20, v20, v22
    v_mov_b32 v51, v20
    s_waitcnt vmcnt(0)
L_xchk:
    v_xor_b32 v40, s53, v40
    v_xor_b32 v41, s54, v41
    v_xor_b32 v42, s55, v42
    v_xor_b32 v43, s56, v43
    v_or3_b32 v55, v41, v42, v43
    v_and_b32 v53, 0xff, v40
    v_or_b32 v55, v55, v53
    v_cmp_ne_u32 vcc, 0, v55
    s_cbranch_vccz L_xok
    buffer_load_dwordx4 v[40:43], v54, s[36:39], 0 offen offset:2048 sc1
    s_waitcnt vmcnt(0)
    s_sub_u32 s72, s72, 1
    s_cbranch_scc1 L_end
    s_branch L_xchk
L_xok:
    v_cmp_ne_u32 vcc, s78, v40
    s_mov_b32 s64, 0
    s_cbranch_vccnz L_xg
    s_mov_b32 s64, 1
L_xg:
    v_lshlrev_b32 v229, 16, v229
    ds_read_b128 v[72:75], v242 offset:0
    ds_read_b128 v[76:79], v242 offset:1024
    ds_read_b128 v[80:83], v242 offset:2048
    ds_read_b128 v[84:87], v242 offset:3072
    ds_read_b128 v[244:247], v242 offset:4096
    ds_read_b128 v[248:251], v242 offset:5120
    ds_read_b128 v[40:43], v242 offset:6144
    ds_read_b128 v[44:47], v242 offset:7168
    v_mov_b32 v232, 0
    v_mov_b32 v233, 0
    v_mov_b32 v234, 0
    v_mov_b32 v235, 0
    v_mov_b32 v6, 0
    v_mov_b32 v7, 0
    v_mov_b32 v8, 0
    v_mov_b32 v9, 0
    v_mov_b32 v252, 0
    v_mov_b32 v253, 0
    v_mov_b32 v254, 0
    v_mov_b32 v255, 0
    v_mov_b32 v10, 0
    v_mov_b32 v11, 0
    v_mov_b32 v12, 0
    v_mov_b32 v13, 0
    v_mov_b32 v14, 0
    v_mov_b32 v15, 0
    v_mov_b32 v16, 0
    v_mov_b32 v17, 0
    v_and_b32 v4, 3, v1
    v_mul_u32_u24 v4, 0x5555, v4
    v_mov_b32 v64, 0
    v_mov_b32 v65, 0
    v_mov_b32 v66, 0
    v_mov_b32 v67, 0
    v_mov_b32 v68, 0
    v_mov_b32 v69, 0
    v_mov_b32 v70, 0
    v_mov_b32 v71, 0
    v_mov_b32 v216, 0
    v_mov_b32 v217, 0
    v_mov_b32 v218, 0
    v_mov_b32 v219, 0
    v_mov_b32 v36, 0
    v_mov_b32 v37, 0
    v_mov_b32 v38, 0
    v_mov_b32 v39, 0
    v_mov_b32 v52, 1.0
    s_nop 1
    v_mov_b32_dpp v68, v52 quad_perm:[0,0,0,0] row_mask:0xf bank_mask:0x5
    v_mov_b32_dpp v69, v52 quad_perm:[0,0,0,0] row_mask:0xf bank_mask:0xa
    v_mov_b32_dpp v70, v52 quad_perm:[0,0,0,0] row_mask:0xf bank_mask:0x5
    v_mov_b32_dpp v71, v52 quad_perm:[0,0,0,0] row_mask:0xf bank_mask:0xa
L_h1pre:
    buffer_load_dword v23, v225, s[36:39], s20 offen offset:12 sc1
    s_waitcnt vmcnt(0)
    v_cmp_eq_u32 vcc, s56, v23
    s_nop 0
    s_bcnt1_i32_b64 s71, vcc
    s_cmp_ge_u32 s71, 16
    s_cbranch_scc1 L_h1go
    s_sub_u32 s72, s72, 1
    s_cbranch_scc1 L_end
    s_sleep 4
    s_branch L_h1pre
L_h1go:
    v_mov_b32 v24, 0
    v_mov_b32 v25, 0
    v_mov_b32 v26, 0
    v_mov_b32 v27, 0
    v_mov_b32 v28, 0
    v_mov_b32 v29, 0
    v_mov_b32 v30, 0
    v_mov_b32 v31, 0
L_h1_rnd:
    buffer_load_dwordx4 v[20:23], v225, s[36:39], s20 offen sc1
    buffer_load_dwordx4 v[56:59], v224, s[36:39], s16 offen sc1
    buffer_load_dwordx4 v[60:63], v224, s[36:39], s16 offen offset:1024 sc1
    s_waitcnt vmcnt(2)
    v_xor_b32 v20, s53, v20
    v_xor_b32 v21, s54, v21
    v_xor_b32 v22, s55, v22
    v_xor_b32 v23, s56, v23
    v_or3_b32 v55, v20, v21, v22
    v_or_b32 v55, v55, v23
    v_and_b32 v55, 0xff, v55
    v_cmp_ne_u32 vcc, 0, v55
    v_or_b32_sdwa v20, v20, v22 dst_sel:DWORD dst_unused:UNUSED_PAD src0_sel:DWORD src1_sel:BYTE_3
    s_waitcnt vmcnt(0)
    s_cbranch_vccnz L_h1_re
    v_pk_max_u16 v55, v56, v57
    v_max_f32_dpp v22, v20, v20 quad_perm:[1,0,3,2] row_mask:0xf bank_mask:0xf
    v_pk_max_u16 v53, v58, v59
    v_pk_max_u16 v55, v55, v60
    v_max_f32_dpp v22, v22, v22 row_ror:8 row_mask:0xf bank_mask:0xf
    v_pk_max_u16 v53, v53, v61
    v_pk_max_u16 v55, v55, v62
    v_max_f32_dpp v22, v22, v22 row_ror:4 row_mask:0xf bank_mask:0xf
    v_mov_b32 v23, v22
    v_pk_max_u16 v53, v53, v63
    v_pk_max_u16 v55, v55, v53
    v_permlane32_swap_b32 v22, v23
    v_max_f32 v22, v22, v23
    v_mov_b32 v23, v22
    v_pk_max_u16 v55, v55, v55 op_sel:[1,0] op_sel_hi:[0,1]
    v_cmp_eq_u32 vcc, -1, v55
    v_permlane16_swap_b32 v22, v23
    s_cbranch_vccnz L_h1_re
    v_max_f32 v22, v22, v23
    v_sub_f32 v20, v20, v22
    v_exp_f32 v20, v20
    s_nop 0
    v_cvt_pk_bf16_f32 v22, 0, v20
    v_cvt_pk_bf16_f32 v23, v20, 0
    v_mul_f32 v21, v22, v21
    v_dot2c_f32_bf16_dpp v25, v22, v56 quad_perm:[0,0,0,0] row_mask:0xf bank_mask:0xf
    v_dot2c_f32_bf16_dpp v24, v23, v56 quad_perm:[0,0,0,0] row_mask:0xf bank_mask:0xf
    v_add_f32_dpp v21, v21, v21 quad_perm:[1,0,3,2] row_mask:0xf bank_mask:0xf
    v_dot2c_f32_bf16_dpp v27, v22, v57 quad_perm:[0,0,0,0] row_mask:0xf bank_mask:0xf
    v_dot2c_f32_bf16_dpp v26, v23, v57 quad_perm:[0,0,0,0] row_mask:0xf bank_mask:0xf
    v_add_f32_dpp v21, v21, v21 row_ror:8 row_mask:0xf bank_mask:0xf
    v_dot2c_f32_bf16_dpp v29, v22, v58 quad_perm:[0,0,0,0] row_mask:0xf bank_mask:0xf
    v_dot2c_f32_bf16_dpp v28, v23, v58 quad_perm:[0,0,0,0] row_mask:0xf bank_mask:0xf
    v_add_f32_dpp v21, v21, v21 row_ror:4 row_mask:0xf bank_mask:0xf
    v_dot2c_f32_bf16_dpp v31, v22, v59 quad_perm:[0,0,0,0] row_mask:0xf bank_mask:0xf
    v_dot2c_f32_bf16_dpp v30, v23, v59 quad_perm:[0,0,0,0] row_mask:0xf bank_mask:0xf
    v_mov_b32 v20, v21
    v_dot2c_f32_bf16_dpp v25, v22, v60 quad_perm:[1,1,1,1] row_mask:0xf bank_mask:0xf
    v_dot2c_f32_bf16_dpp v24, v23, v60 quad_perm:[1,1,1,1] row_mask:0xf bank_mask:0xf
    v_permlane32_swap_b32 v21, v20
    v_dot2c_f32_bf16_dpp v27, v22, v61 quad_perm:[1,1,1,1] row_mask:0xf bank_mask:0xf
    v_dot2c_f32_bf16_dpp v26, v23, v61 quad_perm:[1,1,1,1] row_mask:0xf bank_mask:0xf
    v_add_f32 v21, v21, v20
    v_mov_b32 v20, v21
    v_dot2c_f32_bf16_dpp v29, v22, v62 quad_perm:[1,1,1,1] row_mask:0xf bank_mask:0xf
    v_dot2c_f32_bf16_dpp v28, v23, v62 quad_perm:[1,1,1,1] row_mask:0xf bank_mask:0xf
    v_permlane16_swap_b32 v21, v20
    v_dot2c_f32_bf16_dpp v31, v22, v63 quad_perm:[1,1,1,1] row_mask:0xf bank_mask:0xf
    v_dot2c_f32_bf16_dpp v30, v23, v63 quad_perm:[1,1,1,1] row_mask:0xf bank_mask:0xf
    v_add_f32 v21, v21, v20
    v_permlane32_swap_b32 v24, v25
    v_permlane32_swap_b32 v26, v27
    v_rcp_f32 v21, v21
    v_permlane32_swap_b32 v28, v29
    v_permlane32_swap_b32 v30, v31
    v_add_f32 v24, v24, v25
    v_add_f32 v26, v26, v27
    v_add_f32 v28, v28, v29
    v_add_f32 v30, v30, v31
    v_permlane16_swap_b32 v24, v26
    s_nop 0
    v_permlane16_swap_b32 v28, v30
    v_add_f32 v24, v24, v26
    v_add_f32 v28, v28, v30
    s_nop 0
    v_add_f32_dpp v24, v24, v24 row_ror:4 row_mask:0xf bank_mask:0xf
    v_add_f32_dpp v28, v28, v28 row_ror:4 row_mask:0xf bank_mask:0xf
    s_nop 0
    v_add_f32_dpp v20, v24, v24 row_ror:8 row_mask:0xf bank_mask:0x5
    v_add_f32_dpp v20, v28, v28 row_ror:8 row_mask:0xf bank_mask:0xa
    v_mul_f32 v20, v20, v21
    v_cvt_pk_bf16_f32 v20, 0, v20
    s_nop 1
    v_mov_b32_dpp v232, v20 row_newbcast:0 row_mask:0xf bank_mask:0x5
    v_mov_b32_dpp v233, v20 row_newbcast:0 row_mask:0xf bank_mask:0xa
    v_mov_b32_dpp v234, v20 row_newbcast:1 row_mask:0xf bank_mask:0x5
    v_mov_b32_dpp v235, v20 row_newbcast:1 row_mask:0xf bank_mask:0xa
    v_mov_b32_dpp v6, v20 row_newbcast:2 row_mask:0xf bank_mask:0x5
    v_mov_b32_dpp v7, v20 row_newbcast:2 row_mask:0xf bank_mask:0xa
    v_mov_b32_dpp v8, v20 row_newbcast:3 row_mask:0xf bank_mask:0x5
    v_mov_b32_dpp v9, v20 row_newbcast:3 row_mask:0xf bank_mask:0xa
    v_smfmac_f32_16x16x64_bf16 v[10:13], v[232:235], v[88:95], v4
    v_smfmac_f32_16x16x64_bf16 v[14:17], v[232:235], v[120:127], v4
    v_mov_b32_dpp v252, v20 row_newbcast:4 row_mask:0xf bank_mask:0x5
    v_mov_b32_dpp v253, v20 row_newbcast:4 row_mask:0xf bank_mask:0xa
    v_mov_b32_dpp v254, v20 row_newbcast:5 row_mask:0xf bank_mask:0x5
    v_mov_b32_dpp v255, v20 row_newbcast:5 row_mask:0xf bank_mask:0xa
    v_smfmac_f32_16x16x64_bf16 v[10:13], v[6:9], v[96:103], v4
    v_smfmac_f32_16x16x64_bf16 v[14:17], v[6:9], v[128:135], v4
    v_mov_b32_dpp v232, v20 row_newbcast:6 row_mask:0xf bank_mask:0x5
    v_mov_b32_dpp v233, v20 row_newbcast:6 row_mask:0xf bank_mask:0xa
    v_mov_b32_dpp v234, v20 row_newbcast:7 row_mask:0xf bank_mask:0x5
    v_mov_b32_dpp v235, v20 row_newbcast:7 row_mask:0xf bank_mask:0xa
    v_smfmac_f32_16x16x64_bf16 v[10:13], v[252:255], v[104:111], v4
    v_smfmac_f32_16x16x64_bf16 v[14:17], v[252:255], v[136:143], v4
    v_smfmac_f32_16x16x64_bf16 v[10:13], v[232:235], v[112:119], v4
    v_smfmac_f32_16x16x64_bf16 v[14:17], v[232:235], v[144:151], v4
    s_mov_b32 exec_hi, 0
    s_nop 5
    ds_write_b128 v227, v[10:13] offset:20480
    s_not_b64 exec, exec
    ds_write_b128 v227, v[14:17] offset:20480
    s_mov_b64 exec, -1
    s_waitcnt lgkmcnt(0)
    s_barrier
    ds_read_b128 v[20:23], v228 offset:20480
    s_cmp_eq_u32 s64, 1
    s_waitcnt lgkmcnt(0)
    v_permlane32_swap_b32 v20, v21
    v_permlane32_swap_b32 v22, v23
    v_add_f32 v20, v20, v21
    v_add_f32 v22, v22, v23
    s_nop 1
    v_permlane16_swap_b32 v20, v22
    v_add_f32 v20, v20, v22
    s_nop 1
    v_add_f32_dpp v20, v20, v20 row_ror:8 row_mask:0xf bank_mask:0xf
    s_mov_b32 exec_lo, 0x00ff00ff
    s_mov_b32 exec_hi, 0x00ff00ff
    v_cvt_pk_bf16_f32 v52, 0, v20
    v_min_u32 v52, s60, v52
    s_cbranch_scc0 L_hs_g
    buffer_store_short_d16_hi v52, v222, s[36:39], s21 offen
L_hs_j:
    s_mov_b64 exec, -1
    s_barrier
L_h2:
    s_cmp_lg_u32 s69, 2
    s_cbranch_scc1 L_h2f
    s_cmp_lg_u32 s3, 7
    s_cbranch_scc1 L_end
L_h2f:
L_h2_rnd:
    buffer_load_dwordx4 v[20:23], v230, s[36:39], s24 offen sc1
    buffer_load_dwordx4 v[24:27], v230, s[36:39], s25 offen sc1
    v_mov_b32 v28, 0
    v_mov_b32 v29, 0
    v_mov_b32 v30, 0
    v_mov_b32 v31, 0
    s_waitcnt vmcnt(1)
    v_pk_max_u16 v55, v20, v21
    v_pk_max_u16 v53, v22, v23
    v_pk_max_u16 v55, v55, v53
    s_waitcnt vmcnt(0)
    v_smfmac_f32_16x16x64_bf16 v[28:31], v[68:71], v[20:27], v4
    v_pk_max_u16 v55, v55, v24
    v_pk_max_u16 v55, v55, v25
    v_pk_max_u16 v55, v55, v26
    v_pk_max_u16 v55, v55, v27
    v_pk_max_u16 v55, v55, v55 op_sel:[1,0] op_sel_hi:[0,1]
    v_cmp_eq_u32 vcc, -1, v55
    s_cbranch_vccnz L_h2_re
    s_nop 0
    v_add_f32_dpp v20, v28, v28 row_ror:8 row_mask:0x3 bank_mask:0x3
    v_add_f32_dpp v20, v29, v29 row_ror:8 row_mask:0x3 bank_mask:0xc
    v_add_f32_dpp v20, v30, v30 row_ror:8 row_mask:0xc bank_mask:0x3
    v_add_f32_dpp v20, v31, v31 row_ror:8 row_mask:0xc bank_mask:0xc
    v_add_f32 v20, v20, v229
    v_cvt_pk_bf16_f32 v20, 0, v20
    s_cmp_eq_u32 s69, 2
    v_mov_b32 v50, v20
    s_cbranch_scc1 L_fin0
    v_readfirstlane_b32 s71, v20
    v_mov_b32_dpp v21, v20 row_half_mirror row_mask:0xf bank_mask:0xf
    s_nop 0
    v_subrev_f32 v25, s71, v20
    v_mov_b32 v24, s71
    v_mul_f32 v26, v25, v25
    v_mov_b32_dpp v232, v20 quad_perm:[0,0,0,0] row_mask:0xf bank_mask:0x5
    v_mov_b32_dpp v233, v21 quad_perm:[3,3,3,3] row_mask:0xf bank_mask:0xa
    v_mov_b32_dpp v234, v20 quad_perm:[1,1,1,1] row_mask:0xf bank_mask:0x5
    v_mov_b32_dpp v235, v21 quad_perm:[2,2,2,2] row_mask:0xf bank_mask:0xa
    v_permlane32_swap_b32 v25, v26
    v_add_f32 v25, v25, v26
    v_mov_b32_dpp v6, v20 quad_perm:[2,2,2,2] row_mask:0xf bank_mask:0x5
    v_mov_b32_dpp v7, v21 quad_perm:[1,1,1,1] row_mask:0xf bank_mask:0xa
    v_mov_b32_dpp v8, v20 quad_perm:[3,3,3,3] row_mask:0xf bank_mask:0x5
    v_mov_b32_dpp v9, v21 quad_perm:[0,0,0,0] row_mask:0xf bank_mask:0xa
    v_add_f32_dpp v25, v25, v25 quad_perm:[1,0,3,2] row_mask:0xf bank_mask:0xf
    v_smfmac_f32_16x16x64_bf16 v[216:219], v[232:235], v[152:159], v4
    v_smfmac_f32_16x16x64_bf16 v[36:39], v[232:235], v[184:191], v4
    v_mov_b32_dpp v252, v21 quad_perm:[3,3,3,3] row_mask:0xf bank_mask:0x5
    v_mov_b32_dpp v253, v20 quad_perm:[0,0,0,0] row_mask:0xf bank_mask:0xa
    v_mov_b32_dpp v254, v21 quad_perm:[2,2,2,2] row_mask:0xf bank_mask:0x5
    v_mov_b32_dpp v255, v20 quad_perm:[1,1,1,1] row_mask:0xf bank_mask:0xa
    v_add_f32_dpp v25, v25, v25 quad_perm:[2,3,0,1] row_mask:0xf bank_mask:0xf
    v_smfmac_f32_16x16x64_bf16 v[216:219], v[6:9], v[160:167], v4
    v_smfmac_f32_16x16x64_bf16 v[36:39], v[6:9], v[192:199], v4
    v_mov_b32_dpp v232, v21 quad_perm:[1,1,1,1] row_mask:0xf bank_mask:0x5
    v_mov_b32_dpp v233, v20 quad_perm:[2,2,2,2] row_mask:0xf bank_mask:0xa
    v_mov_b32_dpp v234, v21 quad_perm:[0,0,0,0] row_mask:0xf bank_mask:0x5
    v_mov_b32_dpp v235, v20 quad_perm:[3,3,3,3] row_mask:0xf bank_mask:0xa
    v_add_f32_dpp v25, v25, v25 row_ror:8 row_mask:0xf bank_mask:0xf
    v_smfmac_f32_16x16x64_bf16 v[216:219], v[252:255], v[168:175], v4
    v_smfmac_f32_16x16x64_bf16 v[36:39], v[252:255], v[200:207], v4
    v_add_f32_dpp v25, v25, v25 row_ror:4 row_mask:0xf bank_mask:0xf
    v_mov_b32 v26, v25
    v_smfmac_f32_16x16x64_bf16 v[216:219], v[232:235], v[176:183], v4
    v_smfmac_f32_16x16x64_bf16 v[36:39], v[232:235], v[208:215], v4
    v_permlane16_swap_b32 v25, v26
    v_add_f32 v25, v25, v26
    s_mov_b32 exec_lo, 1
    s_mov_b32 exec_hi, 1
    ds_write_b64 v236, v[24:25] offset:19200
    s_mov_b32 exec_lo, -1
    s_mov_b32 exec_hi, 0
    ds_write_b128 v227, v[216:219] offset:28672
    s_not_b64 exec, exec
    ds_write_b128 v227, v[36:39] offset:28672
    s_mov_b64 exec, -1
    s_waitcnt lgkmcnt(0)
    s_barrier
    ds_read_b128 v[60:63], v237 offset:19200
    ds_read_b128 v[20:23], v239 offset:28672
    ds_read_b128 v[24:27], v239 offset:29184
    ds_read_b128 v[28:31], v239 offset:29696
    ds_read_b128 v[32:35], v239 offset:30208
    s_waitcnt lgkmcnt(4)
    v_readfirstlane_b32 s71, v60
    s_nop 1
    v_subrev_f32 v60, s71, v60
    v_fmamk_f32 v59, v60, 0x42800000, v61
    v_add_f32 v61, v61, v59
    v_fma_f32 v62, v60, v61, v63
    s_waitcnt lgkmcnt(0)
    v_pk_add_f32 v[20:21], v[20:21], v[24:25]
    v_add_f32_dpp v59, v59, v59 quad_perm:[1,0,3,2] row_mask:0xf bank_mask:0xf
    v_pk_add_f32 v[22:23], v[22:23], v[26:27]
    v_add_f32_dpp v62, v62, v62 quad_perm:[1,0,3,2] row_mask:0xf bank_mask:0xf
    v_pk_add_f32 v[28:29], v[28:29], v[32:33]
    v_add_f32_dpp v59, v59, v59 quad_perm:[2,3,0,1] row_mask:0xf bank_mask:0xf
    v_pk_add_f32 v[30:31], v[30:31], v[34:35]
    v_add_f32_dpp v62, v62, v62 quad_perm:[2,3,0,1] row_mask:0xf bank_mask:0xf
    v_pk_add_f32 v[20:21], v[20:21], v[28:29]
    v_add_f32_dpp v59, v59, v59 row_half_mirror row_mask:0xf bank_mask:0xf
    v_pk_add_f32 v[22:23], v[22:23], v[30:31]
    v_add_f32_dpp v62, v62, v62 row_half_mirror row_mask:0xf bank_mask:0xf
    v_mul_f32 v59, 0x3b000000, v59
    v_permlane32_swap_b32 v20, v21
    v_permlane32_swap_b32 v22, v23
    v_mul_f32 v62, 0x3b000000, v62
    v_add_f32 v20, v20, v21
    v_add_f32 v22, v22, v23
    v_fma_f32 v62, -v59, v59, v62
    v_max_f32 v62, 0, v62
    v_permlane16_swap_b32 v20, v22
    v_add_f32 v62, 0x3727c5ac, v62
    v_add_f32 v59, s71, v59
    v_rsq_f32 v62, v62
    v_add_f32 v20, v20, v22
    v_fma_f32 v20, -v59, v51, v20
    v_mul_f32 v20, v20, v62
    s_nop 1
    v_mul_f32_dpp v21, v20, v20 row_ror:8 row_mask:0xf bank_mask:0xf
    v_cvt_pk_bf16_f32 v21, 0, v21
    s_nop 1
    v_mov_b32_dpp v232, v21 row_newbcast:0 row_mask:0xf bank_mask:0x5
    v_mov_b32_dpp v233, v21 row_newbcast:0 row_mask:0xf bank_mask:0xa
    v_mov_b32_dpp v234, v21 row_newbcast:1 row_mask:0xf bank_mask:0x5
    v_mov_b32_dpp v235, v21 row_newbcast:1 row_mask:0xf bank_mask:0xa
    v_mov_b32_dpp v6, v21 row_newbcast:2 row_mask:0xf bank_mask:0x5
    v_mov_b32_dpp v7, v21 row_newbcast:2 row_mask:0xf bank_mask:0xa
    v_mov_b32_dpp v8, v21 row_newbcast:3 row_mask:0xf bank_mask:0x5
    v_mov_b32_dpp v9, v21 row_newbcast:3 row_mask:0xf bank_mask:0xa
    v_smfmac_f32_16x16x64_bf16 v[64:67], v[232:235], v[72:79], v4
    v_mov_b32_dpp v252, v21 row_newbcast:4 row_mask:0xf bank_mask:0x5
    v_mov_b32_dpp v253, v21 row_newbcast:4 row_mask:0xf bank_mask:0xa
    v_mov_b32_dpp v254, v21 row_newbcast:5 row_mask:0xf bank_mask:0x5
    v_mov_b32_dpp v255, v21 row_newbcast:5 row_mask:0xf bank_mask:0xa
    v_smfmac_f32_16x16x64_bf16 v[64:67], v[6:9], v[80:87], v4
    v_mov_b32_dpp v232, v21 row_newbcast:6 row_mask:0xf bank_mask:0x5
    v_mov_b32_dpp v233, v21 row_newbcast:6 row_mask:0xf bank_mask:0xa
    v_mov_b32_dpp v234, v21 row_newbcast:7 row_mask:0xf bank_mask:0x5
    v_mov_b32_dpp v235, v21 row_newbcast:7 row_mask:0xf bank_mask:0xa
    v_smfmac_f32_16x16x64_bf16 v[64:67], v[252:255], v[244:251], v4
    s_nop 0
    v_smfmac_f32_16x16x64_bf16 v[64:67], v[232:235], v[40:47], v4
    s_mov_b32 exec_hi, 0
    s_cmp_eq_u32 s64, 1
    s_nop 5
    v_cvt_pk_bf16_f32 v56, v64, v65
    v_cvt_pk_bf16_f32 v57, v66, v67
    v_pk_min_u16 v56, s60, v56
    v_pk_min_u16 v57, s60, v57
    s_cbranch_scc0 L_ys_g
    buffer_store_dwordx2 v[56:57], v240, s[36:39], s18 offen
L_ys_j:
    s_cmp_lg_u32 s3, s68
    s_cbranch_scc1 L_end
    s_mov_b64 exec, -1
    s_branch L_fin
L_fin0:
    s_cmp_lg_u32 s77, 28
    s_cbranch_scc1 L_fin
    s_mov_b64 exec, 1
    v_mov_b32 v48, s52
    buffer_store_dword v48, v3, s[36:39], 0 offen sc1
    s_mov_b64 exec, -1
L_fin:
    s_and_b32 s71, s77, 3
    s_lshl_b32 s71, s71, 1
    s_lshl_b32 s71, 0x03030303, s71
L_h3_rnd:
    buffer_load_dwordx4 v[20:23], v238, s[36:39], s22 offen sc1
    buffer_load_dwordx4 v[24:27], v238, s[36:39], s23 offen sc1
    v_mov_b32 v28, 0
    v_mov_b32 v29, 0
    v_mov_b32 v30, 0
    v_mov_b32 v31, 0
    s_waitcnt vmcnt(1)
    v_pk_max_u16 v55, v20, v21
    v_pk_max_u16 v53, v22, v23
    v_pk_max_u16 v55, v55, v53
    s_waitcnt vmcnt(0)
    v_smfmac_f32_16x16x64_bf16 v[28:31], v[68:71], v[20:27], v4
    v_pk_max_u16 v55, v55, v24
    v_pk_max_u16 v55, v55, v25
    v_pk_max_u16 v55, v55, v26
    v_pk_max_u16 v55, v55, v27
    v_pk_max_u16 v55, v55, v55 op_sel:[1,0] op_sel_hi:[0,1]
    v_cmp_eq_u32 vcc, -1, v55
    s_cbranch_vccnz L_h3_re
    s_nop 0
    v_add_f32_dpp v20, v28, v28 quad_perm:[2,3,0,1] row_mask:0x3 bank_mask:0xf
    v_add_f32_dpp v21, v29, v29 quad_perm:[2,3,0,1] row_mask:0x3 bank_mask:0xf
    v_add_f32_dpp v20, v30, v30 quad_perm:[2,3,0,1] row_mask:0xc bank_mask:0xf
    v_add_f32_dpp v21, v31, v31 quad_perm:[2,3,0,1] row_mask:0xc bank_mask:0xf
    s_nop 0
    v_add_f32_dpp v20, v20, v20 row_ror:4 row_mask:0xf bank_mask:0xf
    v_add_f32_dpp v21, v21, v21 row_ror:4 row_mask:0xf bank_mask:0xf
    s_nop 0
    v_add_f32_dpp v22, v20, v20 row_ror:8 row_mask:0xf bank_mask:0x3
    v_add_f32_dpp v22, v21, v21 row_ror:8 row_mask:0xf bank_mask:0xc
    v_add_f32 v20, v22, v50
    v_cvt_pk_bf16_f32 v20, 0, v20
    s_mov_b32 exec_lo, s71
    s_mov_b32 exec_hi, s71
    buffer_store_short_d16_hi v20, v241, s[44:47], 0 offen
    s_branch L_end
L_cs:
    v_and_b32 v4, 3, v1
    v_mul_u32_u24 v4, 0x5555, v4
    v_mov_b32 v20, 0
    v_mov_b32 v21, 0
    v_mov_b32 v22, 0
    v_mov_b32 v23, 0
    v_mov_b32 v24, 0
    v_mov_b32 v25, 0
    v_mov_b32 v26, 0
    v_mov_b32 v27, 0
    v_mov_b32 v28, 0
    v_mov_b32 v29, 0
    v_mov_b32 v30, 0
    v_mov_b32 v31, 0
    v_mov_b32 v32, 1.0
    s_waitcnt vmcnt(0)
    s_nop 0
    v_mov_b32_dpp v28, v32 quad_perm:[0,0,0,0] row_mask:0xf bank_mask:0x5
    v_mov_b32_dpp v29, v32 quad_perm:[0,0,0,0] row_mask:0xf bank_mask:0xa
    v_mov_b32_dpp v30, v32 quad_perm:[0,0,0,0] row_mask:0xf bank_mask:0x5
    v_mov_b32_dpp v31, v32 quad_perm:[0,0,0,0] row_mask:0xf bank_mask:0xa
    s_nop 1
    v_smfmac_f32_16x16x64_bf16 v[20:23], v[28:31], v[152:159], v4
    v_smfmac_f32_16x16x64_bf16 v[24:27], v[28:31], v[184:191], v4
    v_smfmac_f32_16x16x64_bf16 v[20:23], v[28:31], v[160:167], v4
    v_smfmac_f32_16x16x64_bf16 v[24:27], v[28:31], v[192:199], v4
    v_smfmac_f32_16x16x64_bf16 v[20:23], v[28:31], v[168:175], v4
    v_smfmac_f32_16x16x64_bf16 v[24:27], v[28:31], v[200:207], v4
    v_smfmac_f32_16x16x64_bf16 v[20:23], v[28:31], v[176:183], v4
    v_smfmac_f32_16x16x64_bf16 v[24:27], v[28:31], v[208:215], v4
    s_mov_b32 exec_hi, 0
    s_nop 5
    ds_write_b128 v227, v[20:23] offset:28672
    s_not_b64 exec, exec
    ds_write_b128 v227, v[24:27] offset:28672
    s_mov_b64 exec, -1
    s_branch L_csr
L_h1_re:
    s_sub_u32 s72, s72, 1
    s_cbranch_scc1 L_end
    s_branch L_h1_rnd
L_h2_re:
    s_sub_u32 s72, s72, 1
    s_cbranch_scc1 L_end
    s_branch L_h2_rnd
L_h3_re:
    s_sub_u32 s72, s72, 1
    s_cbranch_scc1 L_end
    s_branch L_h3_rnd
L_hs_g:
    buffer_store_short_d16_hi v52, v222, s[36:39], s21 offen sc1
    s_branch L_hs_j
L_ys_g:
    buffer_store_dwordx2 v[56:57], v240, s[36:39], s18 offen sc1
    s_branch L_ys_j
L_end:
L_exit:
    s_endpgm
.fill 512, 4, 0xbf800000
.section .rodata,"a"
.p2align 6
.amdhsa_kernel sequential_preLN__gqa_block_cached__glu_gated_bilinear__decode_kernel
  .amdhsa_next_free_vgpr 256
  .amdhsa_next_free_sgpr 102
  .amdhsa_accum_offset 256
  .amdhsa_group_segment_fixed_size 0
  .amdhsa_kernarg_size 96
  .amdhsa_user_sgpr_count 2
  .amdhsa_user_sgpr_kernarg_segment_ptr 1
  .amdhsa_system_sgpr_workgroup_id_x 1
  .amdhsa_float_denorm_mode_32 3
.end_amdhsa_kernel
```
